```python
import torch

def _softmax(x, axis=-1):
    return torch.softmax(x, dim=axis)
def _gelu(x):
    return torch.nn.functional.gelu(x, approximate="tanh")
def _silu(x):
    return torch.nn.functional.silu(x)
def _sigmoid(x):
    return torch.sigmoid(x)
def _layernorm(x, axis=-1, eps=1e-5):
    m = x.mean(dim=axis, keepdim=True)
    v = x.var(dim=axis, keepdim=True, unbiased=False)
    return (x - m) / torch.sqrt(v + eps)
def _scatter_add(tgt, idx, src, axis=0):
    return tgt.clone().index_add_(axis, idx, src)
def _segment_sum(src, seg, n):
    out = torch.zeros((n,) + src.shape[1:], dtype=src.dtype)
    return out.index_add_(0, seg, src)
def _pad(x, pw):
    flat = tuple(v for pair in reversed(pw) for v in pair)
    return torch.nn.functional.pad(x, flat)

kernel_name = 'sequential_preLN__mha_block_cached__mixer_token_mlp__decode'

def setup_inputs():

    _w = (lambda a: (lambda t: t.to(torch.bfloat16) if t.is_floating_point() else t)(torch.as_tensor(a)))
    def _A_setup():
        B, Sq, D = 2, 1, 640
        H, Sk, Dh = 32, 8192, 128
        return {
            "x": _w((lambda *s: torch.randn(*s, dtype=torch.bfloat16) * 0.05)(B, Sq, D)),
            "k_cache": _w((lambda *s: torch.randn(*s, dtype=torch.bfloat16) * 3.2)(B, H, Sk, Dh)),
            "v_cache": _w((lambda *s: torch.randn(*s, dtype=torch.bfloat16) * 0.8)(B, H, Sk, Dh)),
            "wq": _w((lambda *s: torch.randn(*s, dtype=torch.bfloat16) * 3.2)(D, H * Dh) * (D ** -0.5)),
            "wo": _w((lambda *s: torch.randn(*s, dtype=torch.bfloat16) * 0.8)(H * Dh, D) * ((H * Dh) ** -0.5)),
        }
    _A_in = _A_setup()

    def _B_setup():
        B, S, D, F = 2, 1, 640, 1728
        return {
            "x": _w((lambda *s: torch.randn(*s, dtype=torch.bfloat16) * 0.05)(B, S, D)),
            "w1": _w((lambda *s: torch.randn(*s, dtype=torch.bfloat16) * 1.6)(S, F) * (S ** -0.5)),
            "b1": _w((lambda *s: torch.randn(*s, dtype=torch.bfloat16) * 1.6)(F) * 0.02),
            "w2": _w((lambda *s: torch.randn(*s, dtype=torch.bfloat16) * 1.6)(F, S) * (F ** -0.5)),
            "b2": _w((lambda *s: torch.randn(*s, dtype=torch.bfloat16) * 0.8)(S) * 0.02),
        }
    _B_in = _B_setup()

    return {
        "A_x": _A_in["x"],
        "A_k_cache": _A_in["k_cache"],
        "A_v_cache": _A_in["v_cache"],
        "A_wq": _A_in["wq"],
        "A_wo": _A_in["wo"],
        "B_x": _B_in["x"],
        "B_w1": _B_in["w1"],
        "B_b1": _B_in["b1"],
        "B_w2": _B_in["w2"],
        "B_b2": _B_in["b2"],
    }

def reference(A_x, A_k_cache, A_v_cache, A_wq, A_wo, B_x, B_w1, B_b1, B_w2, B_b2):
    def _A_ref(x, k_cache, v_cache, wq, wo):
        B, Sq, D = x.shape
        H, Dh = 32, 128
        q = (lambda x, *d: x.permute(*d))((x @ wq).reshape(B, Sq, H, Dh), 0, 2, 1, 3)
        scores = torch.einsum("bhqd,bhkd->bhqk", q, k_cache) * (Dh ** -0.5)
        p = _softmax(scores, axis=-1)
        o = torch.einsum("bhqk,bhkd->bhqd", p, v_cache)
        return (lambda x, *d: x.permute(*d))(o, 0, 2, 1, 3).reshape(B, Sq, H * Dh) @ wo

    def _B_ref(x, w1, b1, w2, b2):
        B, S, D = x.shape
        h = _layernorm(x, axis=-1)
        u = torch.einsum("bsd,sf->bdf", h, w1) + b1
        u = _gelu(u)
        y = torch.einsum("bdf,fs->bds", u, w2) + b2
        return (lambda x, *d: x.permute(*d))(y, 0, 2, 1)

    x = A_x
    h = x + _A_ref(_layernorm(x, axis=-1), A_k_cache, A_v_cache, A_wq, A_wo)
    h2 = h + _B_ref(_layernorm(h, axis=-1), B_w1, B_b1, B_w2, B_b2)
    return h2
```

```asm
; @launch grid=(256,1,1) block=(256,1,1) lds=57344
.amdgcn_target "amdgcn-amd-amdhsa--gfx950"
.text
.globl sequential_preLN__mha_block_cached__mixer_token_mlp__decode_kernel
.p2align 8
.type sequential_preLN__mha_block_cached__mixer_token_mlp__decode_kernel,@function
sequential_preLN__mha_block_cached__mixer_token_mlp__decode_kernel:
    s_cmp_ge_u32 s2, 256
    s_cbranch_scc1 Lend
    s_load_dwordx16 s[8:23], s[0:1], 0
    s_load_dwordx8 s[24:31], s[0:1], 64
    s_load_dwordx2 s[32:33], s[0:1], 96
    v_lshrrev_b32 v40, 6, v0
    v_and_b32 v1, 63, v0
    v_readfirstlane_b32 s34, v40
    v_lshlrev_b32 v2, 4, v1
    s_and_b32 s52, s2, 7
    s_lshl_b32 s52, s52, 2
    s_lshr_b32 s53, s2, 6
    s_add_u32 s35, s52, s53
    s_bfe_u32 s36, s2, 0x10005
    s_bfe_u32 s37, s2, 0x20003
    s_lshl_b32 s52, s36, 5
    s_add_u32 s52, s52, s35
    s_lshl_b32 s54, s52, 2
    s_add_u32 s54, s54, s37
    s_lshl_b32 s53, s54, 19
    s_lshl_b32 s55, s34, 17
    s_add_u32 s53, s53, s55
    s_mul_i32 s55, s34, 8192
    s_lshr_b32 s56, s2, 3
    s_mul_i32 s56, s56, 16384
    s_add_u32 s55, s55, s56
    s_and_b32 s56, s2, 7
    s_mul_i32 s56, s56, 6144
    s_add_u32 s55, s55, s56
    v_add_u32 v3, s55, v2
    v_and_b32 v3, 0x1ffff, v3
    s_mov_b32 s39, 0
    s_cmp_eq_u32 s2, 0
    s_cselect_b32 s39, 1, s39
    s_cmp_eq_u32 s2, 34
    s_cselect_b32 s39, 1, s39
    v_lshrrev_b32 v64, 4, v1
    v_and_b32 v65, 15, v1
    s_and_b32 s55, s2, 7
    s_mul_i32 s55, s55, 80
    s_lshl_b32 s56, s34, 2
    s_add_u32 s55, s55, s56
    v_add_u32 v66, s55, v64
    v_lshrrev_b32 v40, 3, v65
    v_mul_u32_u24 v40, 640, v40
    v_add_lshl_u32 v72, v40, v66, 1
    v_lshlrev_b32 v66, 13, v66
    v_lshl_add_u32 v66, v65, 4, v66
    s_lshr_b32 s56, s2, 3
    s_lshl_b32 s56, s56, 8
    v_add_u32 v66, s56, v66
    v_lshrrev_b32 v40, 5, v1
    v_mul_u32_u24 v40, 1280, v40
    v_and_b32 v67, 31, v1
    v_lshl_add_u32 v68, v67, 4, v40
    v_lshl_add_u32 v67, v67, 3, v40
    s_mov_b32 s51, 0x20000
    s_mov_b32 s47, 0x20000
    s_mov_b32 s43, 0x20000
    s_lshl_b32 s55, s36, 15
    s_add_u32 s55, s55, 131072
    s_mov_b32 s46, 14336
    s_waitcnt lgkmcnt(0)
    s_add_u32 s10, s10, s53
    s_addc_u32 s11, s11, 0
    s_add_u32 s44, s32, s55
    s_addc_u32 s45, s33, 0
    s_cmp_eq_u32 s39, 0
    s_cbranch_scc1 Lnz1
    v_mov_b32 v44, 0
    v_mov_b32 v45, 0
    v_mov_b32 v46, 0
    v_mov_b32 v47, 0
    v_lshlrev_b32 v40, 4, v0
    s_movk_i32 s55, 0
    buffer_store_dwordx4 v[44:47], v40, s[44:47], s55 offen sc1
    s_movk_i32 s55, 4096
    buffer_store_dwordx4 v[44:47], v40, s[44:47], s55 offen sc1
    s_movk_i32 s55, 8192
    buffer_store_dwordx4 v[44:47], v40, s[44:47], s55 offen sc1
    s_movk_i32 s55, 12288
    buffer_store_dwordx4 v[44:47], v40, s[44:47], s55 offen sc1
Lnz1:
    global_load_dwordx4 v[96:99], v3, s[10:11] nt
    v_add_u32 v3, 5120, v3
    v_and_b32 v3, 0x1ffff, v3
    global_load_dwordx4 v[100:103], v3, s[10:11] nt
    v_add_u32 v3, 5120, v3
    v_and_b32 v3, 0x1ffff, v3
    global_load_dwordx4 v[104:107], v3, s[10:11] nt
    v_add_u32 v3, 5120, v3
    v_and_b32 v3, 0x1ffff, v3
    global_load_dwordx4 v[108:111], v3, s[10:11] nt
    v_add_u32 v3, 5120, v3
    v_and_b32 v3, 0x1ffff, v3
    global_load_dwordx4 v[204:207], v68, s[8:9]
    global_load_dwordx4 v[208:211], v68, s[8:9] offset:512
    global_load_dwordx2 v[212:213], v67, s[8:9] offset:1024
    global_load_dwordx4 v[216:219], v66, s[14:15] nt
    v_add_u32 v66, 0x20000, v66
    global_load_dwordx4 v[220:223], v66, s[14:15] nt
    v_add_u32 v66, 0x20000, v66
    global_load_dwordx4 v[224:227], v66, s[14:15] nt
    v_add_u32 v66, 0x20000, v66
    global_load_dwordx4 v[228:231], v66, s[14:15] nt
    v_add_u32 v66, 0x20000, v66
    global_load_dwordx4 v[232:235], v66, s[14:15] nt
    global_load_ushort v73, v72, s[8:9] offset:32
    global_load_ushort v74, v72, s[8:9] offset:64
    global_load_ushort v75, v72, s[8:9] offset:96
    global_load_ushort v76, v72, s[8:9] offset:128
    global_load_ushort v72, v72, s[8:9] offset:0
    global_load_dwordx4 v[112:115], v3, s[10:11] nt
    v_add_u32 v3, 5120, v3
    v_and_b32 v3, 0x1ffff, v3
    global_load_dwordx4 v[116:119], v3, s[10:11] nt
    v_add_u32 v3, 5120, v3
    v_and_b32 v3, 0x1ffff, v3
    global_load_dwordx4 v[120:123], v3, s[10:11] nt
    v_add_u32 v3, 5120, v3
    v_and_b32 v3, 0x1ffff, v3
    global_load_dwordx4 v[124:127], v3, s[10:11] nt
    v_add_u32 v3, 5120, v3
    v_and_b32 v3, 0x1ffff, v3
    global_load_dwordx4 v[128:131], v3, s[10:11] nt
    v_add_u32 v3, 5120, v3
    v_and_b32 v3, 0x1ffff, v3
    global_load_dwordx4 v[132:135], v3, s[10:11] nt
    v_add_u32 v3, 5120, v3
    v_and_b32 v3, 0x1ffff, v3
    global_load_dwordx4 v[136:139], v3, s[10:11] nt
    v_add_u32 v3, 5120, v3
    v_and_b32 v3, 0x1ffff, v3
    global_load_dwordx4 v[140:143], v3, s[10:11] nt
    v_add_u32 v3, 5120, v3
    v_and_b32 v3, 0x1ffff, v3
    s_load_dword s38, s[32:33], 0
    s_add_u32 s12, s12, s53
    s_addc_u32 s13, s13, 0
    v_bfe_u32 v40, v65, 1, 2
    v_and_b32 v41, 1, v65
    v_lshlrev_b32 v41, 4, v41
    v_mov_b32 v42, 0xffff
    v_lshlrev_b32 v41, v41, v42
    v_cmp_eq_u32 vcc, 0, v40
    s_nop 1
    v_cndmask_b32 v4, 0, v41, vcc
    v_cmp_eq_u32 vcc, 1, v40
    s_nop 1
    v_cndmask_b32 v5, 0, v41, vcc
    v_cmp_eq_u32 vcc, 2, v40
    s_nop 1
    v_cndmask_b32 v6, 0, v41, vcc
    v_cmp_eq_u32 vcc, 3, v40
    s_nop 1
    v_cndmask_b32 v7, 0, v41, vcc
    s_and_b32 s55, s54, 3
    s_mul_i32 s55, s55, 3584
    s_add_u32 s40, s44, s55
    s_addc_u32 s41, s45, 0
    s_mov_b32 s42, 3424
    s_mov_b32 s4, 0
    s_mov_b32 s5, -1
    s_mov_b32 s6, 0xff00ff00
    s_mov_b32 s7, 0xff00ff00
    s_lshl_b32 s55, s35, 7
    s_lshl_b32 s53, s34, 5
    s_add_u32 s55, s55, s53
    v_add_u32 v92, s55, v64
    v_mul_u32_u24 v92, 1280, v92
    v_lshl_add_u32 v92, v65, 4, v92
    v_mov_b32 v40, 0
    ds_write_b32 v40, v40 offset:53760
    s_waitcnt vmcnt(18)
    v_lshlrev_b32 v236, 16, v204
    v_and_b32 v237, 0xffff0000, v204
    v_lshlrev_b32 v238, 16, v205
    v_and_b32 v239, 0xffff0000, v205
    v_lshlrev_b32 v240, 16, v206
    v_and_b32 v241, 0xffff0000, v206
    v_lshlrev_b32 v242, 16, v207
    v_and_b32 v243, 0xffff0000, v207
    v_lshlrev_b32 v244, 16, v208
    v_and_b32 v245, 0xffff0000, v208
    v_lshlrev_b32 v246, 16, v209
    v_and_b32 v247, 0xffff0000, v209
    v_lshlrev_b32 v248, 16, v210
    v_and_b32 v249, 0xffff0000, v210
    v_lshlrev_b32 v250, 16, v211
    v_and_b32 v251, 0xffff0000, v211
    v_lshlrev_b32 v252, 16, v212
    v_and_b32 v253, 0xffff0000, v212
    v_lshlrev_b32 v254, 16, v213
    v_and_b32 v255, 0xffff0000, v213
    v_readlane_b32 s55, v236, 0
    v_readlane_b32 s56, v236, 32
    s_nop 0
    v_mov_b32 v40, s55
    v_mov_b32 v41, s56
    v_cndmask_b32 v42, v40, v41, s[4:5]
    v_cndmask_b32 v43, v40, v41, s[6:7]
    v_sub_f32 v236, v236, v42
    v_sub_f32 v237, v237, v42
    v_sub_f32 v238, v238, v42
    v_sub_f32 v239, v239, v42
    v_sub_f32 v240, v240, v42
    v_sub_f32 v241, v241, v42
    v_sub_f32 v242, v242, v42
    v_sub_f32 v243, v243, v42
    v_sub_f32 v244, v244, v42
    v_sub_f32 v245, v245, v42
    v_sub_f32 v246, v246, v42
    v_sub_f32 v247, v247, v42
    v_sub_f32 v248, v248, v42
    v_sub_f32 v249, v249, v42
    v_sub_f32 v250, v250, v42
    v_sub_f32 v251, v251, v42
    v_sub_f32 v252, v252, v42
    v_sub_f32 v253, v253, v42
    v_sub_f32 v254, v254, v42
    v_sub_f32 v255, v255, v42
    v_add_f32 v50, v236, v237
    v_mul_f32 v51, v236, v236
    v_fmac_f32 v51, v237, v237
    v_add_f32 v50, v50, v238
    v_fmac_f32 v51, v238, v238
    v_add_f32 v50, v50, v239
    v_fmac_f32 v51, v239, v239
    v_add_f32 v50, v50, v240
    v_fmac_f32 v51, v240, v240
    v_add_f32 v50, v50, v241
    v_fmac_f32 v51, v241, v241
    v_add_f32 v50, v50, v242
    v_fmac_f32 v51, v242, v242
    v_add_f32 v50, v50, v243
    v_fmac_f32 v51, v243, v243
    v_add_f32 v50, v50, v244
    v_fmac_f32 v51, v244, v244
    v_add_f32 v50, v50, v245
    v_fmac_f32 v51, v245, v245
    v_add_f32 v50, v50, v246
    v_fmac_f32 v51, v246, v246
    v_add_f32 v50, v50, v247
    v_fmac_f32 v51, v247, v247
    v_add_f32 v50, v50, v248
    v_fmac_f32 v51, v248, v248
    v_add_f32 v50, v50, v249
    v_fmac_f32 v51, v249, v249
    v_add_f32 v50, v50, v250
    v_fmac_f32 v51, v250, v250
    v_add_f32 v50, v50, v251
    v_fmac_f32 v51, v251, v251
    v_add_f32 v50, v50, v252
    v_fmac_f32 v51, v252, v252
    v_add_f32 v50, v50, v253
    v_fmac_f32 v51, v253, v253
    v_add_f32 v50, v50, v254
    v_fmac_f32 v51, v254, v254
    v_add_f32 v50, v50, v255
    v_fmac_f32 v51, v255, v255
    s_nop 1
    v_add_f32_dpp v50, v50, v50 row_ror:8 row_mask:0xf bank_mask:0xf
    v_add_f32_dpp v51, v51, v51 row_ror:8 row_mask:0xf bank_mask:0xf
    s_nop 0
    v_add_f32_dpp v50, v50, v50 row_ror:4 row_mask:0xf bank_mask:0xf
    v_add_f32_dpp v51, v51, v51 row_ror:4 row_mask:0xf bank_mask:0xf
    s_nop 0
    v_add_f32_dpp v50, v50, v50 row_ror:2 row_mask:0xf bank_mask:0xf
    v_add_f32_dpp v51, v51, v51 row_ror:2 row_mask:0xf bank_mask:0xf
    s_nop 0
    v_add_f32_dpp v50, v50, v50 row_ror:1 row_mask:0xf bank_mask:0xf
    v_add_f32_dpp v51, v51, v51 row_ror:1 row_mask:0xf bank_mask:0xf
    s_nop 0
    v_add_f32_dpp v50, v50, v50 row_bcast:15 row_mask:0xa bank_mask:0xf
    v_add_f32_dpp v51, v51, v51 row_bcast:15 row_mask:0xa bank_mask:0xf
    s_nop 0
    v_readlane_b32 s55, v50, 31
    v_readlane_b32 s56, v50, 63
    v_readlane_b32 s57, v51, 31
    v_readlane_b32 s58, v51, 63
    v_mov_b32 v40, s55
    v_mov_b32 v41, s56
    v_mov_b32 v44, s57
    v_mov_b32 v45, s58
    v_cndmask_b32 v52, v40, v41, s[6:7]
    v_cndmask_b32 v53, v44, v45, s[6:7]
    v_mul_f32 v52, 0x3acccccd, v52
    v_mul_f32 v53, 0x3acccccd, v53
    v_fma_f32 v53, -v52, v52, v53
    v_add_f32 v52, v43, v52
    v_max_f32 v53, 0, v53
    v_cvt_pk_bf16_f32 v52, 0, v52
    v_cvt_pk_bf16_f32 v53, 0, v53
    v_add_f32 v53, 0x3727c5ac, v53
    v_cvt_pk_bf16_f32 v53, 0, v53
    v_sqrt_f32 v53, v53
    s_nop 0
    v_cvt_pk_bf16_f32 v53, 0, v53
    v_rcp_f32 v53, v53
    s_nop 0
    s_waitcnt vmcnt(8)
    s_mov_b32 s50, 3456
    s_lshl_b32 s55, s34, 10
    v_add_u32 v93, s55, v2
    s_mov_b32 s48, s20
    s_mov_b32 s49, s21
    buffer_load_dwordx4 v[20:23], v2, s[48:51], s55 offen nt
    s_mov_b32 s48, s22
    s_mov_b32 s49, s23
    buffer_load_dwordx4 v[24:27], v2, s[48:51], s55 offen nt
    s_mov_b32 s48, s24
    s_mov_b32 s49, s25
    buffer_load_dwordx4 v[16:19], v2, s[48:51], s55 offen nt
    v_mov_b32 v87, 0
    global_load_ushort v87, v87, s[26:27]
    global_load_dwordx4 v[144:147], v3, s[10:11] nt
    v_add_u32 v3, 5120, v3
    v_and_b32 v3, 0x1ffff, v3
    global_load_dwordx4 v[148:151], v3, s[10:11] nt
    v_add_u32 v3, 5120, v3
    v_and_b32 v3, 0x1ffff, v3
    global_load_dwordx4 v[152:155], v3, s[10:11] nt
    v_add_u32 v3, 5120, v3
    v_and_b32 v3, 0x1ffff, v3
    global_load_dwordx4 v[156:159], v3, s[10:11] nt
    v_add_u32 v3, 5120, v3
    v_and_b32 v3, 0x1ffff, v3
    v_lshlrev_b32 v72, 16, v72
    v_sub_f32 v72, v72, v52
    v_cvt_pk_bf16_f32 v72, 0, v72
    v_mul_f32 v72, v72, v53
    v_cvt_pk_bf16_f32 v72, v72, v72
    v_and_b32 v8, v72, v4
    v_and_b32 v9, v72, v5
    v_and_b32 v10, v72, v6
    v_and_b32 v11, v72, v7
    s_nop 1
    v_mfma_f32_16x16x32_bf16 v[28:31], v[8:11], v[216:219], 0
    v_lshlrev_b32 v73, 16, v73
    v_sub_f32 v73, v73, v52
    v_cvt_pk_bf16_f32 v73, 0, v73
    v_mul_f32 v73, v73, v53
    v_cvt_pk_bf16_f32 v73, v73, v73
    v_and_b32 v12, v73, v4
    v_and_b32 v13, v73, v5
    v_and_b32 v14, v73, v6
    v_and_b32 v15, v73, v7
    s_nop 1
    v_mfma_f32_16x16x32_bf16 v[28:31], v[12:15], v[220:223], v[28:31]
    v_lshlrev_b32 v74, 16, v74
    v_sub_f32 v74, v74, v52
    v_cvt_pk_bf16_f32 v74, 0, v74
    v_mul_f32 v74, v74, v53
    v_cvt_pk_bf16_f32 v74, v74, v74
    v_and_b32 v8, v74, v4
    v_and_b32 v9, v74, v5
    v_and_b32 v10, v74, v6
    v_and_b32 v11, v74, v7
    s_nop 1
    v_mfma_f32_16x16x32_bf16 v[28:31], v[8:11], v[224:227], v[28:31]
    v_lshlrev_b32 v75, 16, v75
    v_sub_f32 v75, v75, v52
    v_cvt_pk_bf16_f32 v75, 0, v75
    v_mul_f32 v75, v75, v53
    v_cvt_pk_bf16_f32 v75, v75, v75
    v_and_b32 v12, v75, v4
    v_and_b32 v13, v75, v5
    v_and_b32 v14, v75, v6
    v_and_b32 v15, v75, v7
    s_nop 1
    v_mfma_f32_16x16x32_bf16 v[28:31], v[12:15], v[228:231], v[28:31]
    v_lshlrev_b32 v76, 16, v76
    v_sub_f32 v76, v76, v52
    v_cvt_pk_bf16_f32 v76, 0, v76
    v_mul_f32 v76, v76, v53
    v_cvt_pk_bf16_f32 v76, v76, v76
    v_and_b32 v8, v76, v4
    v_and_b32 v9, v76, v5
    v_and_b32 v10, v76, v6
    v_and_b32 v11, v76, v7
    s_nop 1
    v_mfma_f32_16x16x32_bf16 v[28:31], v[8:11], v[232:235], v[28:31]
    s_lshl_b32 s55, s34, 10
    v_add_u32 v40, s55, v2
    s_lshl_b32 s55, s34, 8
    v_lshl_add_u32 v41, v65, 4, s55
    v_lshl_add_u32 v41, v64, 10, v41
    s_nop 2
    ds_write_b128 v40, v[28:31] offset:16384
    global_load_dwordx4 v[160:163], v3, s[10:11] nt
    v_add_u32 v3, 5120, v3
    v_and_b32 v3, 0x1ffff, v3
    global_load_dwordx4 v[164:167], v3, s[10:11] nt
    v_add_u32 v3, 5120, v3
    v_and_b32 v3, 0x1ffff, v3
    global_load_dwordx4 v[168:171], v3, s[10:11] nt
    v_add_u32 v3, 5120, v3
    v_and_b32 v3, 0x1ffff, v3
    global_load_dwordx4 v[172:175], v3, s[10:11] nt
    v_add_u32 v3, 5120, v3
    v_and_b32 v3, 0x1ffff, v3
    global_load_dwordx4 v[176:179], v3, s[10:11] nt
    v_add_u32 v3, 5120, v3
    v_and_b32 v3, 0x1ffff, v3
    global_load_dwordx4 v[180:183], v3, s[10:11] nt
    v_add_u32 v3, 5120, v3
    v_and_b32 v3, 0x1ffff, v3
    global_load_dwordx4 v[184:187], v3, s[10:11] nt
    v_add_u32 v3, 5120, v3
    v_and_b32 v3, 0x1ffff, v3
    global_load_dwordx4 v[188:191], v3, s[10:11] nt
    v_add_u32 v3, 5120, v3
    v_and_b32 v3, 0x1ffff, v3
    s_waitcnt vmcnt(12)
    v_lshlrev_b32 v87, 16, v87
    ds_write_b128 v93, v[20:23] offset:4096
    ds_write_b128 v93, v[24:27] offset:8192
    ds_write_b128 v93, v[16:19] offset:12288
    s_waitcnt lgkmcnt(0)
    s_barrier
    s_mul_i32 s38, s38, 1664525
    s_add_u32 s38, s38, 1013904223
    ds_read_b128 v[44:47], v41 offset:16384
    s_lshr_b32 s55, s2, 3
    s_lshl_b32 s55, s55, 1
    s_lshr_b32 s56, s34, 1
    s_add_u32 s55, s55, s56
    s_lshl_b32 s55, s55, 3
    s_and_b32 s56, s2, 7
    s_add_u32 s55, s55, s56
    s_lshl_b32 s55, s55, 9
    s_and_b32 s56, s34, 1
    s_lshl_b32 s56, s56, 8
    s_add_u32 s55, s55, s56
    s_add_u32 s55, s55, 262144
    v_lshl_add_u32 v42, v65, 4, s55
    s_and_b32 s62, s38, 15
    v_mov_b32 v43, s62
    s_waitcnt lgkmcnt(0)
    v_mov_b32 v48, v44
    v_mov_b32 v49, v45
    v_mov_b32 v50, v46
    v_mov_b32 v51, v47
    s_nop 0
    v_permlane32_swap_b32 v44, v48
    v_permlane32_swap_b32 v45, v49
    v_permlane32_swap_b32 v46, v50
    v_permlane32_swap_b32 v47, v51
    v_add_f32 v44, v44, v48
    v_add_f32 v45, v45, v49
    v_add_f32 v46, v46, v50
    v_add_f32 v47, v47, v51
    v_mov_b32 v48, v44
    v_mov_b32 v49, v45
    v_mov_b32 v50, v46
    v_mov_b32 v51, v47
    s_nop 0
    v_permlane16_swap_b32 v44, v48
    v_permlane16_swap_b32 v45, v49
    v_permlane16_swap_b32 v46, v50
    v_permlane16_swap_b32 v47, v51
    v_add_f32 v44, v44, v48
    v_add_f32 v45, v45, v49
    v_add_f32 v46, v46, v50
    v_add_f32 v47, v47, v51
    v_add_u32 v44, 8, v44
    v_add_u32 v45, 8, v45
    v_add_u32 v46, 8, v46
    v_add_u32 v47, 8, v47
    v_bfi_b32 v44, 15, v43, v44
    v_bfi_b32 v45, 15, v43, v45
    v_bfi_b32 v46, 15, v43, v46
    v_bfi_b32 v47, 15, v43, v47
    s_mov_b64 exec, 0xffff
    global_store_dwordx4 v42, v[44:47], s[32:33] sc1
    s_mov_b64 exec, -1
    s_cmp_eq_u32 s39, 0
    s_cbranch_scc1 Lnf2
    s_cmp_lg_u32 s34, 2
    s_cbranch_scc1 Lnf2
    v_mov_b32 v48, s38
    v_mov_b32 v49, s38
    v_mov_b32 v50, s38
    v_mov_b32 v51, s38
    s_lshl_b32 s55, s36, 8
    s_add_u32 s55, s55, 4096
    v_mov_b32 v52, s55
    s_mov_b64 exec, 1
    global_store_dwordx4 v52, v[48:51], s[32:33] sc1
    s_mov_b64 exec, -1
Lnf2:
    s_lshl_b32 s55, s35, 1
    s_add_u32 s55, s55, s36
    s_lshl_b32 s55, s55, 2
    s_add_u32 s55, s55, s34
    s_lshl_b32 s55, s55, 10
    s_add_u32 s55, s55, 262144
    v_add_u32 v66, s55, v2
    s_lshl_b32 s55, s34, 10
    v_lshl_add_u32 v67, v1, 4, s55
    s_lshl_b32 s55, s2, 2
    s_add_u32 s55, s55, s34
    s_lshl_b32 s55, s55, 1
    s_add_u32 s56, s55, 13824
    s_lshl_b32 s56, s56, 16
    s_add_u32 s57, s55, 15872
    s_add_u32 s58, s55, 45568
    s_cmp_ge_u32 s55, 1024
    s_cselect_b32 s57, s58, s57
    s_lshl_b32 s57, s57, 16
    s_add_u32 s58, s55, 47616
    s_lshl_b32 s58, s58, 16
    s_add_u32 s59, s56, 0x10000
    s_add_u32 s60, s57, 0x10000
    s_add_u32 s61, s58, 0x10000
    v_mov_b32 v80, 0
    v_mov_b32 v81, 0
    v_mov_b32 v82, 0
    v_mov_b32 v83, 0
    v_mov_b32 v84, 0
    v_mov_b32 v85, 0
    v_lshlrev_b32 v86, 2, v1
    s_waitcnt vmcnt(7)
    global_load_dwordx4 v[192:195], v3, s[10:11] nt
    v_add_u32 v3, 5120, v3
    v_and_b32 v3, 0x1ffff, v3
    s_call_b64 s[30:31], LtabA
    s_waitcnt vmcnt(7)
    global_load_dwordx4 v[196:199], v3, s[10:11] nt
    v_add_u32 v3, 5120, v3
    v_and_b32 v3, 0x1ffff, v3
    s_call_b64 s[30:31], LtabB
    s_waitcnt vmcnt(7)
    global_load_dwordx4 v[200:203], v3, s[10:11] nt
    v_add_u32 v3, 5120, v3
    v_and_b32 v3, 0x1ffff, v3
    s_call_b64 s[30:31], LtabC
    s_waitcnt vmcnt(7)
    global_load_dwordx4 v[204:207], v3, s[10:11] nt
    v_add_u32 v3, 5120, v3
    v_and_b32 v3, 0x1ffff, v3
    s_call_b64 s[30:31], LtabA
    s_waitcnt vmcnt(7)
    global_load_dwordx4 v[208:211], v3, s[10:11] nt
    v_add_u32 v3, 5120, v3
    v_and_b32 v3, 0x1ffff, v3
    s_call_b64 s[30:31], LtabB
    global_load_dwordx4 v[56:59], v66, s[32:33] offset:0 sc1
    s_waitcnt vmcnt(8)
    global_load_dwordx4 v[212:215], v3, s[10:11] nt
    v_add_u32 v3, 5120, v3
    v_and_b32 v3, 0x1ffff, v3
    s_call_b64 s[30:31], LtabC
    s_waitcnt vmcnt(8)
    global_load_dwordx4 v[216:219], v3, s[10:11] nt
    v_add_u32 v3, 5120, v3
    v_and_b32 v3, 0x1ffff, v3
    s_call_b64 s[30:31], LtabA
    s_waitcnt vmcnt(7)
    global_load_dwordx4 v[220:223], v3, s[10:11] nt
    v_add_u32 v3, 5120, v3
    v_and_b32 v3, 0x1ffff, v3
    s_call_b64 s[30:31], LtabB
    s_waitcnt vmcnt(7)
    global_load_dwordx4 v[224:227], v3, s[10:11] nt
    v_add_u32 v3, 5120, v3
    v_and_b32 v3, 0x1ffff, v3
    s_call_b64 s[30:31], LtabC
    s_waitcnt vmcnt(7)
    global_load_dwordx4 v[228:231], v3, s[10:11] nt
    v_add_u32 v3, 5120, v3
    v_and_b32 v3, 0x1ffff, v3
    s_call_b64 s[30:31], LtabA
    s_waitcnt vmcnt(7)
    global_load_dwordx4 v[232:235], v3, s[10:11] nt
    v_add_u32 v3, 5120, v3
    v_and_b32 v3, 0x1ffff, v3
    s_call_b64 s[30:31], LtabB
    s_waitcnt vmcnt(6)
    s_mov_b32 s3, 0x40000
Lr3:
    v_xor_b32 v40, s38, v56
    v_xor_b32 v41, s38, v57
    v_or_b32 v40, v40, v41
    v_xor_b32 v41, s38, v58
    v_or_b32 v40, v40, v41
    v_xor_b32 v41, s38, v59
    v_or_b32 v40, v40, v41
    v_and_b32 v40, 15, v40
    v_cmp_ne_u32 vcc, 0, v40
    s_cbranch_vccz Lo4
    s_sub_u32 s3, s3, 1
    s_cbranch_scc1 Lo4
    s_sleep 1
    global_load_dwordx4 v[56:59], v66, s[32:33] offset:0 sc1
    s_waitcnt vmcnt(0)
    s_branch Lr3
Lo4:
    v_and_b32 v56, -16, v56
    v_and_b32 v57, -16, v57
    v_and_b32 v58, -16, v58
    v_and_b32 v59, -16, v59
    ds_write_b128 v67, v[56:59] offset:0
    global_load_dwordx4 v[236:239], v3, s[10:11] nt
    v_add_u32 v3, 5120, v3
    v_and_b32 v3, 0x1ffff, v3
    global_load_dwordx4 v[240:243], v3, s[10:11] nt
    v_add_u32 v3, 5120, v3
    v_and_b32 v3, 0x1ffff, v3
    global_load_dwordx4 v[244:247], v3, s[10:11] nt
    v_add_u32 v3, 5120, v3
    v_and_b32 v3, 0x1ffff, v3
    global_load_dwordx4 v[248:251], v3, s[10:11] nt
    v_add_u32 v3, 5120, v3
    v_and_b32 v3, 0x1ffff, v3
    global_load_dwordx4 v[252:255], v3, s[10:11] nt
    v_add_u32 v3, 5120, v3
    v_and_b32 v3, 0x1ffff, v3
    v_lshlrev_b32 v93, 4, v65
    s_waitcnt lgkmcnt(0)
    s_barrier
    ds_read_b128 v[40:43], v93 offset:0
    ds_read_b128 v[44:47], v93 offset:256
    ds_read_b128 v[48:51], v93 offset:512
    ds_read_b128 v[52:55], v93 offset:768
    s_waitcnt lgkmcnt(2)
    v_mov_b32 v32, v40
    v_mov_b32 v33, v41
    v_mov_b32 v34, v42
    v_mov_b32 v35, v43
    v_mov_b32 v36, v44
    v_mov_b32 v37, v45
    v_mov_b32 v38, v46
    v_mov_b32 v39, v47
    s_waitcnt lgkmcnt(0)
    v_add_f32 v32, v32, v48
    v_add_f32 v33, v33, v49
    v_add_f32 v34, v34, v50
    v_add_f32 v35, v35, v51
    v_add_f32 v36, v36, v52
    v_add_f32 v37, v37, v53
    v_add_f32 v38, v38, v54
    v_add_f32 v39, v39, v55
    ds_read_b128 v[40:43], v93 offset:1024
    ds_read_b128 v[44:47], v93 offset:1280
    ds_read_b128 v[48:51], v93 offset:1536
    ds_read_b128 v[52:55], v93 offset:1792
    s_waitcnt lgkmcnt(2)
    v_add_f32 v32, v32, v40
    v_add_f32 v33, v33, v41
    v_add_f32 v34, v34, v42
    v_add_f32 v35, v35, v43
    v_add_f32 v36, v36, v44
    v_add_f32 v37, v37, v45
    v_add_f32 v38, v38, v46
    v_add_f32 v39, v39, v47
    s_waitcnt lgkmcnt(0)
    v_add_f32 v32, v32, v48
    v_add_f32 v33, v33, v49
    v_add_f32 v34, v34, v50
    v_add_f32 v35, v35, v51
    v_add_f32 v36, v36, v52
    v_add_f32 v37, v37, v53
    v_add_f32 v38, v38, v54
    v_add_f32 v39, v39, v55
    ds_read_b128 v[40:43], v93 offset:2048
    ds_read_b128 v[44:47], v93 offset:2304
    ds_read_b128 v[48:51], v93 offset:2560
    ds_read_b128 v[52:55], v93 offset:2816
    s_waitcnt lgkmcnt(2)
    v_add_f32 v32, v32, v40
    v_add_f32 v33, v33, v41
    v_add_f32 v34, v34, v42
    v_add_f32 v35, v35, v43
    v_add_f32 v36, v36, v44
    v_add_f32 v37, v37, v45
    v_add_f32 v38, v38, v46
    v_add_f32 v39, v39, v47
    s_waitcnt lgkmcnt(0)
    v_add_f32 v32, v32, v48
    v_add_f32 v33, v33, v49
    v_add_f32 v34, v34, v50
    v_add_f32 v35, v35, v51
    v_add_f32 v36, v36, v52
    v_add_f32 v37, v37, v53
    v_add_f32 v38, v38, v54
    v_add_f32 v39, v39, v55
    ds_read_b128 v[40:43], v93 offset:3072
    ds_read_b128 v[44:47], v93 offset:3328
    ds_read_b128 v[48:51], v93 offset:3584
    ds_read_b128 v[52:55], v93 offset:3840
    s_waitcnt lgkmcnt(2)
    v_add_f32 v32, v32, v40
    v_add_f32 v33, v33, v41
    v_add_f32 v34, v34, v42
    v_add_f32 v35, v35, v43
    v_add_f32 v36, v36, v44
    v_add_f32 v37, v37, v45
    v_add_f32 v38, v38, v46
    v_add_f32 v39, v39, v47
    s_waitcnt lgkmcnt(0)
    v_add_f32 v32, v32, v48
    v_add_f32 v33, v33, v49
    v_add_f32 v34, v34, v50
    v_add_f32 v35, v35, v51
    v_add_f32 v36, v36, v52
    v_add_f32 v37, v37, v53
    v_add_f32 v38, v38, v54
    v_add_f32 v39, v39, v55
    v_cvt_pk_bf16_f32 v16, v32, v33
    v_cvt_pk_bf16_f32 v17, v34, v35
    v_cvt_pk_bf16_f32 v18, v36, v37
    v_cvt_pk_bf16_f32 v19, v38, v39
    s_mov_b32 s4, 0xcccccccc
    s_mov_b32 s5, 0xcccccccc
    s_mov_b32 s6, 0xaaaaaaaa
    s_mov_b32 s7, 0xaaaaaaaa
    v_dot2_f32_bf16 v93, v96, v16, 0
    v_dot2_f32_bf16 v93, v97, v17, v93
    v_dot2_f32_bf16 v93, v98, v18, v93
    v_dot2_f32_bf16 v93, v99, v19, v93
    s_waitcnt vmcnt(5)
    global_load_dwordx4 v[96:99], v3, s[10:11] nt
    v_add_u32 v3, 5120, v3
    v_and_b32 v3, 0x1ffff, v3
    v_dot2_f32_bf16 v94, v100, v16, 0
    v_dot2_f32_bf16 v94, v101, v17, v94
    v_dot2_f32_bf16 v94, v102, v18, v94
    v_dot2_f32_bf16 v94, v103, v19, v94
    v_add_f32_dpp v32, v93, v93 row_mirror row_mask:0xf bank_mask:0x3
    s_waitcnt vmcnt(5)
    global_load_dwordx4 v[100:103], v3, s[10:11] nt
    v_add_u32 v3, 5120, v3
    v_and_b32 v3, 0x1ffff, v3
    v_dot2_f32_bf16 v93, v104, v16, 0
    v_dot2_f32_bf16 v93, v105, v17, v93
    v_dot2_f32_bf16 v93, v106, v18, v93
    v_dot2_f32_bf16 v93, v107, v19, v93
    v_add_f32_dpp v33, v94, v94 row_mirror row_mask:0xf bank_mask:0x3
    s_call_b64 s[30:31], LtabC
    v_dot2_f32_bf16 v94, v108, v16, 0
    v_dot2_f32_bf16 v94, v109, v17, v94
    v_dot2_f32_bf16 v94, v110, v18, v94
    v_dot2_f32_bf16 v94, v111, v19, v94
    v_add_f32_dpp v34, v93, v93 row_mirror row_mask:0xf bank_mask:0x3
    s_waitcnt vmcnt(5)
    global_load_dwordx4 v[104:107], v3, s[10:11] nt
    v_add_u32 v3, 5120, v3
    v_and_b32 v3, 0x1ffff, v3
    v_dot2_f32_bf16 v93, v112, v16, 0
    v_dot2_f32_bf16 v93, v113, v17, v93
    v_dot2_f32_bf16 v93, v114, v18, v93
    v_dot2_f32_bf16 v93, v115, v19, v93
    v_add_f32_dpp v35, v94, v94 row_mirror row_mask:0xf bank_mask:0x3
    v_dot2_f32_bf16 v94, v116, v16, 0
    v_dot2_f32_bf16 v94, v117, v17, v94
    v_dot2_f32_bf16 v94, v118, v18, v94
    v_dot2_f32_bf16 v94, v119, v19, v94
    v_add_f32_dpp v36, v93, v93 row_mirror row_mask:0xf bank_mask:0x3
    s_waitcnt vmcnt(5)
    global_load_dwordx4 v[108:111], v3, s[10:11] nt
    v_add_u32 v3, 5120, v3
    v_and_b32 v3, 0x1ffff, v3
    s_call_b64 s[30:31], LtabA
    v_dot2_f32_bf16 v93, v120, v16, 0
    v_dot2_f32_bf16 v93, v121, v17, v93
    v_dot2_f32_bf16 v93, v122, v18, v93
    v_dot2_f32_bf16 v93, v123, v19, v93
    v_add_f32_dpp v37, v94, v94 row_mirror row_mask:0xf bank_mask:0x3
    v_dot2_f32_bf16 v94, v124, v16, 0
    v_dot2_f32_bf16 v94, v125, v17, v94
    v_dot2_f32_bf16 v94, v126, v18, v94
    v_dot2_f32_bf16 v94, v127, v19, v94
    v_add_f32_dpp v38, v93, v93 row_mirror row_mask:0xf bank_mask:0x3
    s_waitcnt vmcnt(5)
    global_load_dwordx4 v[112:115], v3, s[10:11] nt
    v_add_u32 v3, 5120, v3
    v_and_b32 v3, 0x1ffff, v3
    v_dot2_f32_bf16 v93, v128, v16, 0
    v_dot2_f32_bf16 v93, v129, v17, v93
    v_dot2_f32_bf16 v93, v130, v18, v93
    v_dot2_f32_bf16 v93, v131, v19, v93
    v_add_f32_dpp v39, v94, v94 row_mirror row_mask:0xf bank_mask:0x3
    s_call_b64 s[30:31], LtabB
    v_dot2_f32_bf16 v94, v132, v16, 0
    v_dot2_f32_bf16 v94, v133, v17, v94
    v_dot2_f32_bf16 v94, v134, v18, v94
    v_dot2_f32_bf16 v94, v135, v19, v94
    v_add_f32_dpp v32, v93, v93 row_mirror row_mask:0xf bank_mask:0xc
    s_waitcnt vmcnt(5)
    global_load_dwordx4 v[116:119], v3, s[10:11] nt
    v_add_u32 v3, 5120, v3
    v_and_b32 v3, 0x1ffff, v3
    v_dot2_f32_bf16 v93, v136, v16, 0
    v_dot2_f32_bf16 v93, v137, v17, v93
    v_dot2_f32_bf16 v93, v138, v18, v93
    v_dot2_f32_bf16 v93, v139, v19, v93
    v_add_f32_dpp v33, v94, v94 row_mirror row_mask:0xf bank_mask:0xc
    v_dot2_f32_bf16 v94, v140, v16, 0
    v_dot2_f32_bf16 v94, v141, v17, v94
    v_dot2_f32_bf16 v94, v142, v18, v94
    v_dot2_f32_bf16 v94, v143, v19, v94
    v_add_f32_dpp v34, v93, v93 row_mirror row_mask:0xf bank_mask:0xc
    s_waitcnt vmcnt(5)
    global_load_dwordx4 v[120:123], v3, s[10:11] nt
    v_add_u32 v3, 5120, v3
    v_and_b32 v3, 0x1ffff, v3
    s_call_b64 s[30:31], LtabC
    v_dot2_f32_bf16 v93, v144, v16, 0
    v_dot2_f32_bf16 v93, v145, v17, v93
    v_dot2_f32_bf16 v93, v146, v18, v93
    v_dot2_f32_bf16 v93, v147, v19, v93
    v_add_f32_dpp v35, v94, v94 row_mirror row_mask:0xf bank_mask:0xc
    v_dot2_f32_bf16 v94, v148, v16, 0
    v_dot2_f32_bf16 v94, v149, v17, v94
    v_dot2_f32_bf16 v94, v150, v18, v94
    v_dot2_f32_bf16 v94, v151, v19, v94
    v_add_f32_dpp v36, v93, v93 row_mirror row_mask:0xf bank_mask:0xc
    s_waitcnt vmcnt(5)
    global_load_dwordx4 v[124:127], v3, s[10:11] nt
    v_add_u32 v3, 5120, v3
    v_and_b32 v3, 0x1ffff, v3
    v_dot2_f32_bf16 v93, v152, v16, 0
    v_dot2_f32_bf16 v93, v153, v17, v93
    v_dot2_f32_bf16 v93, v154, v18, v93
    v_dot2_f32_bf16 v93, v155, v19, v93
    v_add_f32_dpp v37, v94, v94 row_mirror row_mask:0xf bank_mask:0xc
    s_call_b64 s[30:31], LtabA
    v_dot2_f32_bf16 v94, v156, v16, 0
    v_dot2_f32_bf16 v94, v157, v17, v94
    v_dot2_f32_bf16 v94, v158, v18, v94
    v_dot2_f32_bf16 v94, v159, v19, v94
    v_add_f32_dpp v38, v93, v93 row_mirror row_mask:0xf bank_mask:0xc
    s_waitcnt vmcnt(5)
    global_load_dwordx4 v[128:131], v3, s[10:11] nt
    v_add_u32 v3, 5120, v3
    v_and_b32 v3, 0x1ffff, v3
    s_nop 2
    v_add_f32_dpp v39, v94, v94 row_mirror row_mask:0xf bank_mask:0xc
    s_nop 1
    v_add_f32_dpp v40, v32, v32 row_half_mirror row_mask:0xf bank_mask:0x5
    v_add_f32_dpp v40, v36, v36 row_half_mirror row_mask:0xf bank_mask:0xa
    v_add_f32_dpp v41, v33, v33 row_half_mirror row_mask:0xf bank_mask:0x5
    v_add_f32_dpp v41, v37, v37 row_half_mirror row_mask:0xf bank_mask:0xa
    v_add_f32_dpp v42, v34, v34 row_half_mirror row_mask:0xf bank_mask:0x5
    v_add_f32_dpp v42, v38, v38 row_half_mirror row_mask:0xf bank_mask:0xa
    v_add_f32_dpp v43, v35, v35 row_half_mirror row_mask:0xf bank_mask:0x5
    v_add_f32_dpp v43, v39, v39 row_half_mirror row_mask:0xf bank_mask:0xa
    s_nop 0
    v_add_f32_dpp v44, v40, v40 quad_perm:[2,3,0,1] row_mask:0xf bank_mask:0xf
    v_add_f32_dpp v45, v41, v41 quad_perm:[2,3,0,1] row_mask:0xf bank_mask:0xf
    v_add_f32_dpp v46, v42, v42 quad_perm:[2,3,0,1] row_mask:0xf bank_mask:0xf
    v_add_f32_dpp v47, v43, v43 quad_perm:[2,3,0,1] row_mask:0xf bank_mask:0xf
    v_cndmask_b32 v40, v44, v46, s[4:5]
    v_cndmask_b32 v41, v45, v47, s[4:5]
    s_nop 1
    v_add_f32_dpp v42, v40, v40 quad_perm:[1,0,3,2] row_mask:0xf bank_mask:0xf
    v_add_f32_dpp v43, v41, v41 quad_perm:[1,0,3,2] row_mask:0xf bank_mask:0xf
    v_cndmask_b32 v40, v42, v43, s[6:7]
    v_cvt_pk_bf16_f32 v40, 0, v40
    v_mul_f32 v40, 0x3db504f3, v40
    v_cvt_pk_bf16_f32 v20, 0, v40
    v_dot2_f32_bf16 v93, v160, v16, 0
    v_dot2_f32_bf16 v93, v161, v17, v93
    v_dot2_f32_bf16 v93, v162, v18, v93
    v_dot2_f32_bf16 v93, v163, v19, v93
    v_dot2_f32_bf16 v94, v164, v16, 0
    v_dot2_f32_bf16 v94, v165, v17, v94
    v_dot2_f32_bf16 v94, v166, v18, v94
    v_dot2_f32_bf16 v94, v167, v19, v94
    v_add_f32_dpp v32, v93, v93 row_mirror row_mask:0xf bank_mask:0x3
    s_waitcnt vmcnt(5)
    global_load_dwordx4 v[132:135], v3, s[10:11] nt
    v_add_u32 v3, 5120, v3
    v_and_b32 v3, 0x1ffff, v3
    s_call_b64 s[30:31], LtabB
    v_dot2_f32_bf16 v93, v168, v16, 0
    v_dot2_f32_bf16 v93, v169, v17, v93
    v_dot2_f32_bf16 v93, v170, v18, v93
    v_dot2_f32_bf16 v93, v171, v19, v93
    v_add_f32_dpp v33, v94, v94 row_mirror row_mask:0xf bank_mask:0x3
    v_dot2_f32_bf16 v94, v172, v16, 0
    v_dot2_f32_bf16 v94, v173, v17, v94
    v_dot2_f32_bf16 v94, v174, v18, v94
    v_dot2_f32_bf16 v94, v175, v19, v94
    v_add_f32_dpp v34, v93, v93 row_mirror row_mask:0xf bank_mask:0x3
    s_waitcnt vmcnt(5)
    global_load_dwordx4 v[136:139], v3, s[10:11] nt
    v_add_u32 v3, 5120, v3
    v_and_b32 v3, 0x1ffff, v3
    v_dot2_f32_bf16 v93, v176, v16, 0
    v_dot2_f32_bf16 v93, v177, v17, v93
    v_dot2_f32_bf16 v93, v178, v18, v93
    v_dot2_f32_bf16 v93, v179, v19, v93
    v_add_f32_dpp v35, v94, v94 row_mirror row_mask:0xf bank_mask:0x3
    s_call_b64 s[30:31], LtabC
    v_dot2_f32_bf16 v94, v180, v16, 0
    v_dot2_f32_bf16 v94, v181, v17, v94
    v_dot2_f32_bf16 v94, v182, v18, v94
    v_dot2_f32_bf16 v94, v183, v19, v94
    v_add_f32_dpp v36, v93, v93 row_mirror row_mask:0xf bank_mask:0x3
    s_waitcnt vmcnt(5)
    global_load_dwordx4 v[140:143], v3, s[10:11] nt
    v_add_u32 v3, 5120, v3
    v_and_b32 v3, 0x1ffff, v3
    v_dot2_f32_bf16 v93, v184, v16, 0
    v_dot2_f32_bf16 v93, v185, v17, v93
    v_dot2_f32_bf16 v93, v186, v18, v93
    v_dot2_f32_bf16 v93, v187, v19, v93
    v_add_f32_dpp v37, v94, v94 row_mirror row_mask:0xf bank_mask:0x3
    v_dot2_f32_bf16 v94, v188, v16, 0
    v_dot2_f32_bf16 v94, v189, v17, v94
    v_dot2_f32_bf16 v94, v190, v18, v94
    v_dot2_f32_bf16 v94, v191, v19, v94
    v_add_f32_dpp v38, v93, v93 row_mirror row_mask:0xf bank_mask:0x3
    s_waitcnt vmcnt(5)
    global_load_dwordx4 v[144:147], v3, s[10:11] nt
    v_add_u32 v3, 5120, v3
    v_and_b32 v3, 0x1ffff, v3
    s_call_b64 s[30:31], LtabA
    v_dot2_f32_bf16 v93, v192, v16, 0
    v_dot2_f32_bf16 v93, v193, v17, v93
    v_dot2_f32_bf16 v93, v194, v18, v93
    v_dot2_f32_bf16 v93, v195, v19, v93
    v_add_f32_dpp v39, v94, v94 row_mirror row_mask:0xf bank_mask:0x3
    v_dot2_f32_bf16 v94, v196, v16, 0
    v_dot2_f32_bf16 v94, v197, v17, v94
    v_dot2_f32_bf16 v94, v198, v18, v94
    v_dot2_f32_bf16 v94, v199, v19, v94
    v_add_f32_dpp v32, v93, v93 row_mirror row_mask:0xf bank_mask:0xc
    s_waitcnt vmcnt(5)
    global_load_dwordx4 v[148:151], v3, s[10:11] nt
    v_add_u32 v3, 5120, v3
    v_and_b32 v3, 0x1ffff, v3
    v_dot2_f32_bf16 v93, v200, v16, 0
    v_dot2_f32_bf16 v93, v201, v17, v93
    v_dot2_f32_bf16 v93, v202, v18, v93
    v_dot2_f32_bf16 v93, v203, v19, v93
    v_add_f32_dpp v33, v94, v94 row_mirror row_mask:0xf bank_mask:0xc
    s_call_b64 s[30:31], LtabB
    v_dot2_f32_bf16 v94, v204, v16, 0
    v_dot2_f32_bf16 v94, v205, v17, v94
    v_dot2_f32_bf16 v94, v206, v18, v94
    v_dot2_f32_bf16 v94, v207, v19, v94
    v_add_f32_dpp v34, v93, v93 row_mirror row_mask:0xf bank_mask:0xc
    s_waitcnt vmcnt(5)
    global_load_dwordx4 v[152:155], v3, s[10:11] nt
    v_add_u32 v3, 5120, v3
    v_and_b32 v3, 0x1ffff, v3
    v_dot2_f32_bf16 v93, v208, v16, 0
    v_dot2_f32_bf16 v93, v209, v17, v93
    v_dot2_f32_bf16 v93, v210, v18, v93
    v_dot2_f32_bf16 v93, v211, v19, v93
    v_add_f32_dpp v35, v94, v94 row_mirror row_mask:0xf bank_mask:0xc
    v_dot2_f32_bf16 v94, v212, v16, 0
    v_dot2_f32_bf16 v94, v213, v17, v94
    v_dot2_f32_bf16 v94, v214, v18, v94
    v_dot2_f32_bf16 v94, v215, v19, v94
    v_add_f32_dpp v36, v93, v93 row_mirror row_mask:0xf bank_mask:0xc
    s_waitcnt vmcnt(5)
    global_load_dwordx4 v[156:159], v3, s[10:11] nt
    v_add_u32 v3, 5120, v3
    v_and_b32 v3, 0x1ffff, v3
    s_call_b64 s[30:31], LtabC
    v_dot2_f32_bf16 v93, v216, v16, 0
    v_dot2_f32_bf16 v93, v217, v17, v93
    v_dot2_f32_bf16 v93, v218, v18, v93
    v_dot2_f32_bf16 v93, v219, v19, v93
    v_add_f32_dpp v37, v94, v94 row_mirror row_mask:0xf bank_mask:0xc
    v_dot2_f32_bf16 v94, v220, v16, 0
    v_dot2_f32_bf16 v94, v221, v17, v94
    v_dot2_f32_bf16 v94, v222, v18, v94
    v_dot2_f32_bf16 v94, v223, v19, v94
    v_add_f32_dpp v38, v93, v93 row_mirror row_mask:0xf bank_mask:0xc
    s_waitcnt vmcnt(5)
    global_load_dwordx4 v[160:163], v3, s[10:11] nt
    v_add_u32 v3, 5120, v3
    v_and_b32 v3, 0x1ffff, v3
    s_nop 2
    v_add_f32_dpp v39, v94, v94 row_mirror row_mask:0xf bank_mask:0xc
    s_nop 1
    v_add_f32_dpp v40, v32, v32 row_half_mirror row_mask:0xf bank_mask:0x5
    v_add_f32_dpp v40, v36, v36 row_half_mirror row_mask:0xf bank_mask:0xa
    v_add_f32_dpp v41, v33, v33 row_half_mirror row_mask:0xf bank_mask:0x5
    v_add_f32_dpp v41, v37, v37 row_half_mirror row_mask:0xf bank_mask:0xa
    v_add_f32_dpp v42, v34, v34 row_half_mirror row_mask:0xf bank_mask:0x5
    v_add_f32_dpp v42, v38, v38 row_half_mirror row_mask:0xf bank_mask:0xa
    v_add_f32_dpp v43, v35, v35 row_half_mirror row_mask:0xf bank_mask:0x5
    v_add_f32_dpp v43, v39, v39 row_half_mirror row_mask:0xf bank_mask:0xa
    s_nop 0
    v_add_f32_dpp v44, v40, v40 quad_perm:[2,3,0,1] row_mask:0xf bank_mask:0xf
    v_add_f32_dpp v45, v41, v41 quad_perm:[2,3,0,1] row_mask:0xf bank_mask:0xf
    v_add_f32_dpp v46, v42, v42 quad_perm:[2,3,0,1] row_mask:0xf bank_mask:0xf
    v_add_f32_dpp v47, v43, v43 quad_perm:[2,3,0,1] row_mask:0xf bank_mask:0xf
    v_cndmask_b32 v40, v44, v46, s[4:5]
    v_cndmask_b32 v41, v45, v47, s[4:5]
    s_nop 1
    v_add_f32_dpp v42, v40, v40 quad_perm:[1,0,3,2] row_mask:0xf bank_mask:0xf
    v_add_f32_dpp v43, v41, v41 quad_perm:[1,0,3,2] row_mask:0xf bank_mask:0xf
    v_cndmask_b32 v40, v42, v43, s[6:7]
    v_cvt_pk_bf16_f32 v40, 0, v40
    v_mul_f32 v40, 0x3db504f3, v40
    v_cvt_pk_bf16_f32 v21, 0, v40
    v_dot2_f32_bf16 v93, v224, v16, 0
    v_dot2_f32_bf16 v93, v225, v17, v93
    v_dot2_f32_bf16 v93, v226, v18, v93
    v_dot2_f32_bf16 v93, v227, v19, v93
    s_call_b64 s[30:31], LtabA
    v_dot2_f32_bf16 v94, v228, v16, 0
    v_dot2_f32_bf16 v94, v229, v17, v94
    v_dot2_f32_bf16 v94, v230, v18, v94
    v_dot2_f32_bf16 v94, v231, v19, v94
    v_add_f32_dpp v32, v93, v93 row_mirror row_mask:0xf bank_mask:0x3
    s_waitcnt vmcnt(5)
    global_load_dwordx4 v[164:167], v3, s[10:11] nt
    v_add_u32 v3, 5120, v3
    v_and_b32 v3, 0x1ffff, v3
    v_dot2_f32_bf16 v93, v232, v16, 0
    v_dot2_f32_bf16 v93, v233, v17, v93
    v_dot2_f32_bf16 v93, v234, v18, v93
    v_dot2_f32_bf16 v93, v235, v19, v93
    v_add_f32_dpp v33, v94, v94 row_mirror row_mask:0xf bank_mask:0x3
    v_dot2_f32_bf16 v94, v236, v16, 0
    v_dot2_f32_bf16 v94, v237, v17, v94
    v_dot2_f32_bf16 v94, v238, v18, v94
    v_dot2_f32_bf16 v94, v239, v19, v94
    v_add_f32_dpp v34, v93, v93 row_mirror row_mask:0xf bank_mask:0x3
    s_waitcnt vmcnt(5)
    global_load_dwordx4 v[168:171], v3, s[10:11] nt
    v_add_u32 v3, 5120, v3
    v_and_b32 v3, 0x1ffff, v3
    s_call_b64 s[30:31], LtabB
    v_dot2_f32_bf16 v93, v240, v16, 0
    v_dot2_f32_bf16 v93, v241, v17, v93
    v_dot2_f32_bf16 v93, v242, v18, v93
    v_dot2_f32_bf16 v93, v243, v19, v93
    v_add_f32_dpp v35, v94, v94 row_mirror row_mask:0xf bank_mask:0x3
    v_dot2_f32_bf16 v94, v244, v16, 0
    v_dot2_f32_bf16 v94, v245, v17, v94
    v_dot2_f32_bf16 v94, v246, v18, v94
    v_dot2_f32_bf16 v94, v247, v19, v94
    v_add_f32_dpp v36, v93, v93 row_mirror row_mask:0xf bank_mask:0x3
    s_waitcnt vmcnt(5)
    global_load_dwordx4 v[172:175], v3, s[10:11] nt
    v_add_u32 v3, 5120, v3
    v_and_b32 v3, 0x1ffff, v3
    v_dot2_f32_bf16 v93, v248, v16, 0
    v_dot2_f32_bf16 v93, v249, v17, v93
    v_dot2_f32_bf16 v93, v250, v18, v93
    v_dot2_f32_bf16 v93, v251, v19, v93
    v_add_f32_dpp v37, v94, v94 row_mirror row_mask:0xf bank_mask:0x3
    s_call_b64 s[30:31], LtabC
    v_dot2_f32_bf16 v94, v252, v16, 0
    v_dot2_f32_bf16 v94, v253, v17, v94
    v_dot2_f32_bf16 v94, v254, v18, v94
    v_dot2_f32_bf16 v94, v255, v19, v94
    v_add_f32_dpp v38, v93, v93 row_mirror row_mask:0xf bank_mask:0x3
    v_dot2_f32_bf16 v93, v96, v16, 0
    v_dot2_f32_bf16 v93, v97, v17, v93
    v_dot2_f32_bf16 v93, v98, v18, v93
    v_dot2_f32_bf16 v93, v99, v19, v93
    v_add_f32_dpp v39, v94, v94 row_mirror row_mask:0xf bank_mask:0x3
    s_waitcnt vmcnt(5)
    global_load_dwordx4 v[96:99], v3, s[10:11] nt
    v_add_u32 v3, 5120, v3
    v_and_b32 v3, 0x1ffff, v3
    v_dot2_f32_bf16 v94, v100, v16, 0
    v_dot2_f32_bf16 v94, v101, v17, v94
    v_dot2_f32_bf16 v94, v102, v18, v94
    v_dot2_f32_bf16 v94, v103, v19, v94
    v_add_f32_dpp v32, v93, v93 row_mirror row_mask:0xf bank_mask:0xc
    s_waitcnt vmcnt(5)
    global_load_dwordx4 v[100:103], v3, s[10:11] nt
    v_add_u32 v3, 5120, v3
    v_and_b32 v3, 0x1ffff, v3
    s_call_b64 s[30:31], LtabA
    v_dot2_f32_bf16 v93, v104, v16, 0
    v_dot2_f32_bf16 v93, v105, v17, v93
    v_dot2_f32_bf16 v93, v106, v18, v93
    v_dot2_f32_bf16 v93, v107, v19, v93
    v_add_f32_dpp v33, v94, v94 row_mirror row_mask:0xf bank_mask:0xc
    v_dot2_f32_bf16 v94, v108, v16, 0
    v_dot2_f32_bf16 v94, v109, v17, v94
    v_dot2_f32_bf16 v94, v110, v18, v94
    v_dot2_f32_bf16 v94, v111, v19, v94
    v_add_f32_dpp v34, v93, v93 row_mirror row_mask:0xf bank_mask:0xc
    s_waitcnt vmcnt(5)
    global_load_dwordx4 v[104:107], v3, s[10:11] nt
    v_add_u32 v3, 5120, v3
    v_and_b32 v3, 0x1ffff, v3
    v_dot2_f32_bf16 v93, v112, v16, 0
    v_dot2_f32_bf16 v93, v113, v17, v93
    v_dot2_f32_bf16 v93, v114, v18, v93
    v_dot2_f32_bf16 v93, v115, v19, v93
    v_add_f32_dpp v35, v94, v94 row_mirror row_mask:0xf bank_mask:0xc
    s_call_b64 s[30:31], LtabB
    v_dot2_f32_bf16 v94, v116, v16, 0
    v_dot2_f32_bf16 v94, v117, v17, v94
    v_dot2_f32_bf16 v94, v118, v18, v94
    v_dot2_f32_bf16 v94, v119, v19, v94
    v_add_f32_dpp v36, v93, v93 row_mirror row_mask:0xf bank_mask:0xc
    s_waitcnt vmcnt(5)
    global_load_dwordx4 v[108:111], v3, s[10:11] nt
    v_add_u32 v3, 5120, v3
    v_and_b32 v3, 0x1ffff, v3
    v_dot2_f32_bf16 v93, v120, v16, 0
    v_dot2_f32_bf16 v93, v121, v17, v93
    v_dot2_f32_bf16 v93, v122, v18, v93
    v_dot2_f32_bf16 v93, v123, v19, v93
    v_add_f32_dpp v37, v94, v94 row_mirror row_mask:0xf bank_mask:0xc
    v_dot2_f32_bf16 v94, v124, v16, 0
    v_dot2_f32_bf16 v94, v125, v17, v94
    v_dot2_f32_bf16 v94, v126, v18, v94
    v_dot2_f32_bf16 v94, v127, v19, v94
    v_add_f32_dpp v38, v93, v93 row_mirror row_mask:0xf bank_mask:0xc
    s_waitcnt vmcnt(5)
    global_load_dwordx4 v[112:115], v3, s[10:11] nt
    v_add_u32 v3, 5120, v3
    v_and_b32 v3, 0x1ffff, v3
    s_call_b64 s[30:31], LtabC
    s_nop 2
    v_add_f32_dpp v39, v94, v94 row_mirror row_mask:0xf bank_mask:0xc
    s_nop 1
    v_add_f32_dpp v40, v32, v32 row_half_mirror row_mask:0xf bank_mask:0x5
    v_add_f32_dpp v40, v36, v36 row_half_mirror row_mask:0xf bank_mask:0xa
    v_add_f32_dpp v41, v33, v33 row_half_mirror row_mask:0xf bank_mask:0x5
    v_add_f32_dpp v41, v37, v37 row_half_mirror row_mask:0xf bank_mask:0xa
    v_add_f32_dpp v42, v34, v34 row_half_mirror row_mask:0xf bank_mask:0x5
    v_add_f32_dpp v42, v38, v38 row_half_mirror row_mask:0xf bank_mask:0xa
    v_add_f32_dpp v43, v35, v35 row_half_mirror row_mask:0xf bank_mask:0x5
    v_add_f32_dpp v43, v39, v39 row_half_mirror row_mask:0xf bank_mask:0xa
    s_nop 0
    v_add_f32_dpp v44, v40, v40 quad_perm:[2,3,0,1] row_mask:0xf bank_mask:0xf
    v_add_f32_dpp v45, v41, v41 quad_perm:[2,3,0,1] row_mask:0xf bank_mask:0xf
    v_add_f32_dpp v46, v42, v42 quad_perm:[2,3,0,1] row_mask:0xf bank_mask:0xf
    v_add_f32_dpp v47, v43, v43 quad_perm:[2,3,0,1] row_mask:0xf bank_mask:0xf
    v_cndmask_b32 v40, v44, v46, s[4:5]
    v_cndmask_b32 v41, v45, v47, s[4:5]
    s_nop 1
    v_add_f32_dpp v42, v40, v40 quad_perm:[1,0,3,2] row_mask:0xf bank_mask:0xf
    v_add_f32_dpp v43, v41, v41 quad_perm:[1,0,3,2] row_mask:0xf bank_mask:0xf
    v_cndmask_b32 v40, v42, v43, s[6:7]
    v_cvt_pk_bf16_f32 v40, 0, v40
    v_mul_f32 v40, 0x3db504f3, v40
    v_cvt_pk_bf16_f32 v22, 0, v40
    v_dot2_f32_bf16 v93, v128, v16, 0
    v_dot2_f32_bf16 v93, v129, v17, v93
    v_dot2_f32_bf16 v93, v130, v18, v93
    v_dot2_f32_bf16 v93, v131, v19, v93
    global_load_dwordx4 a[0:3], v92, s[16:17] offset:0 nt
    v_dot2_f32_bf16 v94, v132, v16, 0
    v_dot2_f32_bf16 v94, v133, v17, v94
    v_dot2_f32_bf16 v94, v134, v18, v94
    v_dot2_f32_bf16 v94, v135, v19, v94
    v_add_f32_dpp v32, v93, v93 row_mirror row_mask:0xf bank_mask:0x3
    s_waitcnt vmcnt(6)
    global_load_dwordx4 v[116:119], v3, s[10:11] nt
    v_add_u32 v3, 5120, v3
    v_and_b32 v3, 0x1ffff, v3
    v_dot2_f32_bf16 v93, v136, v16, 0
    v_dot2_f32_bf16 v93, v137, v17, v93
    v_dot2_f32_bf16 v93, v138, v18, v93
    v_dot2_f32_bf16 v93, v139, v19, v93
    v_add_f32_dpp v33, v94, v94 row_mirror row_mask:0xf bank_mask:0x3
    s_waitcnt vmcnt(6)
    global_load_dwordx4 v[120:123], v3, s[10:11] nt
    v_add_u32 v3, 5120, v3
    v_and_b32 v3, 0x1ffff, v3
    global_load_dwordx4 a[4:7], v92, s[16:17] offset:256 nt
    s_call_b64 s[30:31], LtabA
    v_dot2_f32_bf16 v94, v140, v16, 0
    v_dot2_f32_bf16 v94, v141, v17, v94
    v_dot2_f32_bf16 v94, v142, v18, v94
    v_dot2_f32_bf16 v94, v143, v19, v94
    v_add_f32_dpp v34, v93, v93 row_mirror row_mask:0xf bank_mask:0x3
    s_waitcnt vmcnt(7)
    global_load_dwordx4 v[124:127], v3, s[10:11] nt
    v_add_u32 v3, 5120, v3
    v_and_b32 v3, 0x1ffff, v3
    v_dot2_f32_bf16 v93, v144, v16, 0
    v_dot2_f32_bf16 v93, v145, v17, v93
    v_dot2_f32_bf16 v93, v146, v18, v93
    v_dot2_f32_bf16 v93, v147, v19, v93
    v_add_f32_dpp v35, v94, v94 row_mirror row_mask:0xf bank_mask:0x3
    s_waitcnt vmcnt(7)
    global_load_dwordx4 v[128:131], v3, s[10:11] nt
    v_add_u32 v3, 5120, v3
    v_and_b32 v3, 0x1ffff, v3
    global_load_dwordx4 a[8:11], v92, s[16:17] offset:512 nt
    v_dot2_f32_bf16 v94, v148, v16, 0
    v_dot2_f32_bf16 v94, v149, v17, v94
    v_dot2_f32_bf16 v94, v150, v18, v94
    v_dot2_f32_bf16 v94, v151, v19, v94
    v_add_f32_dpp v36, v93, v93 row_mirror row_mask:0xf bank_mask:0x3
    s_waitcnt vmcnt(8)
    global_load_dwordx4 v[132:135], v3, s[10:11] nt
    v_add_u32 v3, 5120, v3
    v_and_b32 v3, 0x1ffff, v3
    s_call_b64 s[30:31], LtabB
    v_dot2_f32_bf16 v93, v152, v16, 0
    v_dot2_f32_bf16 v93, v153, v17, v93
    v_dot2_f32_bf16 v93, v154, v18, v93
    v_dot2_f32_bf16 v93, v155, v19, v93
    v_add_f32_dpp v37, v94, v94 row_mirror row_mask:0xf bank_mask:0x3
    s_waitcnt vmcnt(8)
    global_load_dwordx4 v[136:139], v3, s[10:11] nt
    v_add_u32 v3, 5120, v3
    v_and_b32 v3, 0x1ffff, v3
    global_load_dwordx4 a[12:15], v92, s[16:17] offset:768 nt
    v_dot2_f32_bf16 v94, v156, v16, 0
    v_dot2_f32_bf16 v94, v157, v17, v94
    v_dot2_f32_bf16 v94, v158, v18, v94
    v_dot2_f32_bf16 v94, v159, v19, v94
    v_add_f32_dpp v38, v93, v93 row_mirror row_mask:0xf bank_mask:0x3
    s_waitcnt vmcnt(8)
    global_load_dwordx4 v[140:143], v3, s[10:11] nt
    v_add_u32 v3, 5120, v3
    v_and_b32 v3, 0x1ffff, v3
    v_dot2_f32_bf16 v93, v160, v16, 0
    v_dot2_f32_bf16 v93, v161, v17, v93
    v_dot2_f32_bf16 v93, v162, v18, v93
    v_dot2_f32_bf16 v93, v163, v19, v93
    v_add_f32_dpp v39, v94, v94 row_mirror row_mask:0xf bank_mask:0x3
    s_waitcnt vmcnt(8)
    global_load_dwordx4 v[144:147], v3, s[10:11] nt
    v_add_u32 v3, 5120, v3
    v_and_b32 v3, 0x1ffff, v3
    global_load_dwordx4 a[16:19], v92, s[16:17] offset:1024 nt
    v_add_u32 v92, 5120, v92
    s_call_b64 s[30:31], LtabC
    v_dot2_f32_bf16 v94, v164, v16, 0
    v_dot2_f32_bf16 v94, v165, v17, v94
    v_dot2_f32_bf16 v94, v166, v18, v94
    v_dot2_f32_bf16 v94, v167, v19, v94
    v_add_f32_dpp v32, v93, v93 row_mirror row_mask:0xf bank_mask:0xc
    s_waitcnt vmcnt(8)
    global_load_dwordx4 v[148:151], v3, s[10:11] nt
    v_add_u32 v3, 5120, v3
    v_and_b32 v3, 0x1ffff, v3
    v_dot2_f32_bf16 v93, v168, v16, 0
    v_dot2_f32_bf16 v93, v169, v17, v93
    v_dot2_f32_bf16 v93, v170, v18, v93
    v_dot2_f32_bf16 v93, v171, v19, v93
    v_add_f32_dpp v33, v94, v94 row_mirror row_mask:0xf bank_mask:0xc
    s_waitcnt vmcnt(8)
    global_load_dwordx4 v[152:155], v3, s[10:11] nt
    v_add_u32 v3, 5120, v3
    v_and_b32 v3, 0x1ffff, v3
    global_load_dwordx4 a[20:23], v92, s[16:17] offset:0 nt
    v_dot2_f32_bf16 v94, v172, v16, 0
    v_dot2_f32_bf16 v94, v173, v17, v94
    v_dot2_f32_bf16 v94, v174, v18, v94
    v_dot2_f32_bf16 v94, v175, v19, v94
    v_add_f32_dpp v34, v93, v93 row_mirror row_mask:0xf bank_mask:0xc
    s_waitcnt vmcnt(8)
    global_load_dwordx4 v[156:159], v3, s[10:11] nt
    v_add_u32 v3, 5120, v3
    v_and_b32 v3, 0x1ffff, v3
    s_call_b64 s[30:31], LtabA
    v_dot2_f32_bf16 v93, v96, v16, 0
    v_dot2_f32_bf16 v93, v97, v17, v93
    v_dot2_f32_bf16 v93, v98, v18, v93
    v_dot2_f32_bf16 v93, v99, v19, v93
    v_add_f32_dpp v35, v94, v94 row_mirror row_mask:0xf bank_mask:0xc
    s_waitcnt vmcnt(8)
    global_load_dwordx4 v[160:163], v3, s[10:11] nt
    v_add_u32 v3, 5120, v3
    v_and_b32 v3, 0x1ffff, v3
    global_load_dwordx4 a[24:27], v92, s[16:17] offset:256 nt
    v_dot2_f32_bf16 v94, v100, v16, 0
    v_dot2_f32_bf16 v94, v101, v17, v94
    v_dot2_f32_bf16 v94, v102, v18, v94
    v_dot2_f32_bf16 v94, v103, v19, v94
    v_add_f32_dpp v36, v93, v93 row_mirror row_mask:0xf bank_mask:0xc
    s_waitcnt vmcnt(8)
    global_load_dwordx4 v[164:167], v3, s[10:11] nt
    v_add_u32 v3, 5120, v3
    v_and_b32 v3, 0x1ffff, v3
    v_dot2_f32_bf16 v93, v104, v16, 0
    v_dot2_f32_bf16 v93, v105, v17, v93
    v_dot2_f32_bf16 v93, v106, v18, v93
    v_dot2_f32_bf16 v93, v107, v19, v93
    v_add_f32_dpp v37, v94, v94 row_mirror row_mask:0xf bank_mask:0xc
    s_waitcnt vmcnt(8)
    global_load_dwordx4 v[168:171], v3, s[10:11] nt
    v_add_u32 v3, 5120, v3
    v_and_b32 v3, 0x1ffff, v3
    global_load_dwordx4 a[28:31], v92, s[16:17] offset:512 nt
    s_call_b64 s[30:31], LtabB
    v_dot2_f32_bf16 v94, v108, v16, 0
    v_dot2_f32_bf16 v94, v109, v17, v94
    v_dot2_f32_bf16 v94, v110, v18, v94
    v_dot2_f32_bf16 v94, v111, v19, v94
    v_add_f32_dpp v38, v93, v93 row_mirror row_mask:0xf bank_mask:0xc
    s_waitcnt vmcnt(8)
    global_load_dwordx4 v[172:175], v3, s[10:11] nt
    v_add_u32 v3, 5120, v3
    v_and_b32 v3, 0x1ffff, v3
    s_nop 2
    v_add_f32_dpp v39, v94, v94 row_mirror row_mask:0xf bank_mask:0xc
    s_nop 1
    v_add_f32_dpp v40, v32, v32 row_half_mirror row_mask:0xf bank_mask:0x5
    v_add_f32_dpp v40, v36, v36 row_half_mirror row_mask:0xf bank_mask:0xa
    v_add_f32_dpp v41, v33, v33 row_half_mirror row_mask:0xf bank_mask:0x5
    v_add_f32_dpp v41, v37, v37 row_half_mirror row_mask:0xf bank_mask:0xa
    v_add_f32_dpp v42, v34, v34 row_half_mirror row_mask:0xf bank_mask:0x5
    v_add_f32_dpp v42, v38, v38 row_half_mirror row_mask:0xf bank_mask:0xa
    v_add_f32_dpp v43, v35, v35 row_half_mirror row_mask:0xf bank_mask:0x5
    v_add_f32_dpp v43, v39, v39 row_half_mirror row_mask:0xf bank_mask:0xa
    s_nop 0
    v_add_f32_dpp v44, v40, v40 quad_perm:[2,3,0,1] row_mask:0xf bank_mask:0xf
    v_add_f32_dpp v45, v41, v41 quad_perm:[2,3,0,1] row_mask:0xf bank_mask:0xf
    v_add_f32_dpp v46, v42, v42 quad_perm:[2,3,0,1] row_mask:0xf bank_mask:0xf
    v_add_f32_dpp v47, v43, v43 quad_perm:[2,3,0,1] row_mask:0xf bank_mask:0xf
    v_cndmask_b32 v40, v44, v46, s[4:5]
    v_cndmask_b32 v41, v45, v47, s[4:5]
    s_nop 1
    v_add_f32_dpp v42, v40, v40 quad_perm:[1,0,3,2] row_mask:0xf bank_mask:0xf
    v_add_f32_dpp v43, v41, v41 quad_perm:[1,0,3,2] row_mask:0xf bank_mask:0xf
    v_cndmask_b32 v40, v42, v43, s[6:7]
    v_cvt_pk_bf16_f32 v40, 0, v40
    v_mul_f32 v40, 0x3db504f3, v40
    v_cvt_pk_bf16_f32 v23, 0, v40
    v_dot2_f32_bf16 v93, v112, v16, 0
    v_dot2_f32_bf16 v93, v113, v17, v93
    v_dot2_f32_bf16 v93, v114, v18, v93
    v_dot2_f32_bf16 v93, v115, v19, v93
    s_waitcnt vmcnt(8)
    global_load_dwordx4 v[96:99], v3, s[10:11] nt
    v_add_u32 v3, 5120, v3
    v_and_b32 v3, 0x1ffff, v3
    global_load_dwordx4 a[32:35], v92, s[16:17] offset:768 nt
    v_dot2_f32_bf16 v94, v116, v16, 0
    v_dot2_f32_bf16 v94, v117, v17, v94
    v_dot2_f32_bf16 v94, v118, v18, v94
    v_dot2_f32_bf16 v94, v119, v19, v94
    v_add_f32_dpp v32, v93, v93 row_mirror row_mask:0xf bank_mask:0x3
    s_waitcnt vmcnt(8)
    global_load_dwordx4 v[100:103], v3, s[10:11] nt
    v_add_u32 v3, 5120, v3
    v_and_b32 v3, 0x1ffff, v3
    s_call_b64 s[30:31], LtabC
    v_dot2_f32_bf16 v93, v120, v16, 0
    v_dot2_f32_bf16 v93, v121, v17, v93
    v_dot2_f32_bf16 v93, v122, v18, v93
    v_dot2_f32_bf16 v93, v123, v19, v93
    v_add_f32_dpp v33, v94, v94 row_mirror row_mask:0xf bank_mask:0x3
    s_waitcnt vmcnt(8)
    global_load_dwordx4 v[104:107], v3, s[10:11] nt
    v_add_u32 v3, 5120, v3
    v_and_b32 v3, 0x1ffff, v3
    global_load_dwordx4 a[36:39], v92, s[16:17] offset:1024 nt
    v_add_u32 v92, 5120, v92
    v_dot2_f32_bf16 v94, v124, v16, 0
    v_dot2_f32_bf16 v94, v125, v17, v94
    v_dot2_f32_bf16 v94, v126, v18, v94
    v_dot2_f32_bf16 v94, v127, v19, v94
    v_add_f32_dpp v34, v93, v93 row_mirror row_mask:0xf bank_mask:0x3
    s_waitcnt vmcnt(8)
    global_load_dwordx4 v[108:111], v3, s[10:11] nt
    v_add_u32 v3, 5120, v3
    v_and_b32 v3, 0x1ffff, v3
    v_dot2_f32_bf16 v93, v128, v16, 0
    v_dot2_f32_bf16 v93, v129, v17, v93
    v_dot2_f32_bf16 v93, v130, v18, v93
    v_dot2_f32_bf16 v93, v131, v19, v93
    v_add_f32_dpp v35, v94, v94 row_mirror row_mask:0xf bank_mask:0x3
    s_waitcnt vmcnt(8)
    global_load_dwordx4 v[112:115], v3, s[10:11] nt
    v_add_u32 v3, 5120, v3
    v_and_b32 v3, 0x1ffff, v3
    global_load_dwordx4 a[40:43], v92, s[16:17] offset:0 nt
    s_call_b64 s[30:31], LtabA
    v_dot2_f32_bf16 v94, v132, v16, 0
    v_dot2_f32_bf16 v94, v133, v17, v94
    v_dot2_f32_bf16 v94, v134, v18, v94
    v_dot2_f32_bf16 v94, v135, v19, v94
    v_add_f32_dpp v36, v93, v93 row_mirror row_mask:0xf bank_mask:0x3
    s_waitcnt vmcnt(8)
    global_load_dwordx4 v[116:119], v3, s[10:11] nt
    v_add_u32 v3, 5120, v3
    v_and_b32 v3, 0x1ffff, v3
    v_dot2_f32_bf16 v93, v136, v16, 0
    v_dot2_f32_bf16 v93, v137, v17, v93
    v_dot2_f32_bf16 v93, v138, v18, v93
    v_dot2_f32_bf16 v93, v139, v19, v93
    v_add_f32_dpp v37, v94, v94 row_mirror row_mask:0xf bank_mask:0x3
    s_waitcnt vmcnt(8)
    global_load_dwordx4 v[120:123], v3, s[10:11] nt
    v_add_u32 v3, 5120, v3
    v_and_b32 v3, 0x1ffff, v3
    global_load_dwordx4 a[44:47], v92, s[16:17] offset:256 nt
    v_dot2_f32_bf16 v94, v140, v16, 0
    v_dot2_f32_bf16 v94, v141, v17, v94
    v_dot2_f32_bf16 v94, v142, v18, v94
    v_dot2_f32_bf16 v94, v143, v19, v94
    v_add_f32_dpp v38, v93, v93 row_mirror row_mask:0xf bank_mask:0x3
    s_waitcnt vmcnt(8)
    global_load_dwordx4 v[124:127], v3, s[10:11] nt
    v_add_u32 v3, 5120, v3
    v_and_b32 v3, 0x1ffff, v3
    s_call_b64 s[30:31], LtabB
    v_dot2_f32_bf16 v93, v144, v16, 0
    v_dot2_f32_bf16 v93, v145, v17, v93
    v_dot2_f32_bf16 v93, v146, v18, v93
    v_dot2_f32_bf16 v93, v147, v19, v93
    v_add_f32_dpp v39, v94, v94 row_mirror row_mask:0xf bank_mask:0x3
    s_waitcnt vmcnt(8)
    global_load_dwordx4 v[128:131], v3, s[10:11] nt
    v_add_u32 v3, 5120, v3
    v_and_b32 v3, 0x1ffff, v3
    global_load_dwordx4 a[48:51], v92, s[16:17] offset:512 nt
    v_dot2_f32_bf16 v94, v148, v16, 0
    v_dot2_f32_bf16 v94, v149, v17, v94
    v_dot2_f32_bf16 v94, v150, v18, v94
    v_dot2_f32_bf16 v94, v151, v19, v94
    v_add_f32_dpp v32, v93, v93 row_mirror row_mask:0xf bank_mask:0xc
    s_waitcnt vmcnt(8)
    global_load_dwordx4 v[132:135], v3, s[10:11] nt
    v_add_u32 v3, 5120, v3
    v_and_b32 v3, 0x1ffff, v3
    v_dot2_f32_bf16 v93, v152, v16, 0
    v_dot2_f32_bf16 v93, v153, v17, v93
    v_dot2_f32_bf16 v93, v154, v18, v93
    v_dot2_f32_bf16 v93, v155, v19, v93
    v_add_f32_dpp v33, v94, v94 row_mirror row_mask:0xf bank_mask:0xc
    s_waitcnt vmcnt(8)
    global_load_dwordx4 v[136:139], v3, s[10:11] nt
    v_add_u32 v3, 5120, v3
    v_and_b32 v3, 0x1ffff, v3
    global_load_dwordx4 a[52:55], v92, s[16:17] offset:768 nt
    s_call_b64 s[30:31], LtabC
    v_dot2_f32_bf16 v94, v156, v16, 0
    v_dot2_f32_bf16 v94, v157, v17, v94
    v_dot2_f32_bf16 v94, v158, v18, v94
    v_dot2_f32_bf16 v94, v159, v19, v94
    v_add_f32_dpp v34, v93, v93 row_mirror row_mask:0xf bank_mask:0xc
    s_waitcnt vmcnt(8)
    global_load_dwordx4 v[140:143], v3, s[10:11] nt
    v_add_u32 v3, 5120, v3
    v_and_b32 v3, 0x1ffff, v3
    v_dot2_f32_bf16 v93, v160, v16, 0
    v_dot2_f32_bf16 v93, v161, v17, v93
    v_dot2_f32_bf16 v93, v162, v18, v93
    v_dot2_f32_bf16 v93, v163, v19, v93
    v_add_f32_dpp v35, v94, v94 row_mirror row_mask:0xf bank_mask:0xc
    s_waitcnt vmcnt(8)
    global_load_dwordx4 v[144:147], v3, s[10:11] nt
    v_add_u32 v3, 5120, v3
    v_and_b32 v3, 0x1ffff, v3
    global_load_dwordx4 a[56:59], v92, s[16:17] offset:1024 nt
    v_add_u32 v92, 5120, v92
    v_dot2_f32_bf16 v94, v164, v16, 0
    v_dot2_f32_bf16 v94, v165, v17, v94
    v_dot2_f32_bf16 v94, v166, v18, v94
    v_dot2_f32_bf16 v94, v167, v19, v94
    v_add_f32_dpp v36, v93, v93 row_mirror row_mask:0xf bank_mask:0xc
    s_waitcnt vmcnt(8)
    global_load_dwordx4 v[148:151], v3, s[10:11] nt
    v_add_u32 v3, 5120, v3
    v_and_b32 v3, 0x1ffff, v3
    s_call_b64 s[30:31], LtabA
    v_dot2_f32_bf16 v93, v168, v16, 0
    v_dot2_f32_bf16 v93, v169, v17, v93
    v_dot2_f32_bf16 v93, v170, v18, v93
    v_dot2_f32_bf16 v93, v171, v19, v93
    v_add_f32_dpp v37, v94, v94 row_mirror row_mask:0xf bank_mask:0xc
    s_waitcnt vmcnt(8)
    global_load_dwordx4 v[152:155], v3, s[10:11] nt
    v_add_u32 v3, 5120, v3
    v_and_b32 v3, 0x1ffff, v3
    global_load_dwordx4 a[60:63], v92, s[16:17] offset:0 nt
    v_dot2_f32_bf16 v94, v172, v16, 0
    v_dot2_f32_bf16 v94, v173, v17, v94
    v_dot2_f32_bf16 v94, v174, v18, v94
    v_dot2_f32_bf16 v94, v175, v19, v94
    v_add_f32_dpp v38, v93, v93 row_mirror row_mask:0xf bank_mask:0xc
    s_waitcnt vmcnt(8)
    global_load_dwordx4 v[156:159], v3, s[10:11] nt
    v_add_u32 v3, 5120, v3
    v_and_b32 v3, 0x1ffff, v3
    s_nop 2
    v_add_f32_dpp v39, v94, v94 row_mirror row_mask:0xf bank_mask:0xc
    s_nop 1
    v_add_f32_dpp v40, v32, v32 row_half_mirror row_mask:0xf bank_mask:0x5
    v_add_f32_dpp v40, v36, v36 row_half_mirror row_mask:0xf bank_mask:0xa
    v_add_f32_dpp v41, v33, v33 row_half_mirror row_mask:0xf bank_mask:0x5
    v_add_f32_dpp v41, v37, v37 row_half_mirror row_mask:0xf bank_mask:0xa
    v_add_f32_dpp v42, v34, v34 row_half_mirror row_mask:0xf bank_mask:0x5
    v_add_f32_dpp v42, v38, v38 row_half_mirror row_mask:0xf bank_mask:0xa
    v_add_f32_dpp v43, v35, v35 row_half_mirror row_mask:0xf bank_mask:0x5
    v_add_f32_dpp v43, v39, v39 row_half_mirror row_mask:0xf bank_mask:0xa
    s_nop 0
    v_add_f32_dpp v44, v40, v40 quad_perm:[2,3,0,1] row_mask:0xf bank_mask:0xf
    v_add_f32_dpp v45, v41, v41 quad_perm:[2,3,0,1] row_mask:0xf bank_mask:0xf
    v_add_f32_dpp v46, v42, v42 quad_perm:[2,3,0,1] row_mask:0xf bank_mask:0xf
    v_add_f32_dpp v47, v43, v43 quad_perm:[2,3,0,1] row_mask:0xf bank_mask:0xf
    v_cndmask_b32 v40, v44, v46, s[4:5]
    v_cndmask_b32 v41, v45, v47, s[4:5]
    s_nop 1
    v_add_f32_dpp v42, v40, v40 quad_perm:[1,0,3,2] row_mask:0xf bank_mask:0xf
    v_add_f32_dpp v43, v41, v41 quad_perm:[1,0,3,2] row_mask:0xf bank_mask:0xf
    v_cndmask_b32 v40, v42, v43, s[6:7]
    v_cvt_pk_bf16_f32 v40, 0, v40
    v_mul_f32 v40, 0x3db504f3, v40
    v_cvt_pk_bf16_f32 v24, 0, v40
    v_dot2_f32_bf16 v93, v96, v16, 0
    v_dot2_f32_bf16 v93, v97, v17, v93
    v_dot2_f32_bf16 v93, v98, v18, v93
    v_dot2_f32_bf16 v93, v99, v19, v93
    s_waitcnt vmcnt(8)
    global_load_dwordx4 v[160:163], v3, s[10:11] nt
    v_add_u32 v3, 5120, v3
    v_and_b32 v3, 0x1ffff, v3
    global_load_dwordx4 a[64:67], v92, s[16:17] offset:256 nt
    s_call_b64 s[30:31], LtabB
    v_dot2_f32_bf16 v94, v100, v16, 0
    v_dot2_f32_bf16 v94, v101, v17, v94
    v_dot2_f32_bf16 v94, v102, v18, v94
    v_dot2_f32_bf16 v94, v103, v19, v94
    v_add_f32_dpp v32, v93, v93 row_mirror row_mask:0xf bank_mask:0x3
    s_waitcnt vmcnt(8)
    global_load_dwordx4 v[164:167], v3, s[10:11] nt
    v_add_u32 v3, 5120, v3
    v_and_b32 v3, 0x1ffff, v3
    v_dot2_f32_bf16 v93, v104, v16, 0
    v_dot2_f32_bf16 v93, v105, v17, v93
    v_dot2_f32_bf16 v93, v106, v18, v93
    v_dot2_f32_bf16 v93, v107, v19, v93
    v_add_f32_dpp v33, v94, v94 row_mirror row_mask:0xf bank_mask:0x3
    s_waitcnt vmcnt(8)
    global_load_dwordx4 v[168:171], v3, s[10:11] nt
    v_add_u32 v3, 5120, v3
    v_and_b32 v3, 0x1ffff, v3
    global_load_dwordx4 a[68:71], v92, s[16:17] offset:512 nt
    v_dot2_f32_bf16 v94, v108, v16, 0
    v_dot2_f32_bf16 v94, v109, v17, v94
    v_dot2_f32_bf16 v94, v110, v18, v94
    v_dot2_f32_bf16 v94, v111, v19, v94
    v_add_f32_dpp v34, v93, v93 row_mirror row_mask:0xf bank_mask:0x3
    s_waitcnt vmcnt(8)
    global_load_dwordx4 v[172:175], v3, s[10:11] nt
    v_add_u32 v3, 5120, v3
    v_and_b32 v3, 0x1ffff, v3
    s_call_b64 s[30:31], LtabC
    v_dot2_f32_bf16 v93, v112, v16, 0
    v_dot2_f32_bf16 v93, v113, v17, v93
    v_dot2_f32_bf16 v93, v114, v18, v93
    v_dot2_f32_bf16 v93, v115, v19, v93
    v_add_f32_dpp v35, v94, v94 row_mirror row_mask:0xf bank_mask:0x3
    s_waitcnt vmcnt(8)
    global_load_dwordx4 v[96:99], v3, s[10:11] nt
    v_add_u32 v3, 5120, v3
    v_and_b32 v3, 0x1ffff, v3
    global_load_dwordx4 a[72:75], v92, s[16:17] offset:768 nt
    v_dot2_f32_bf16 v94, v116, v16, 0
    v_dot2_f32_bf16 v94, v117, v17, v94
    v_dot2_f32_bf16 v94, v118, v18, v94
    v_dot2_f32_bf16 v94, v119, v19, v94
    v_add_f32_dpp v36, v93, v93 row_mirror row_mask:0xf bank_mask:0x3
    s_waitcnt vmcnt(8)
    global_load_dwordx4 v[100:103], v3, s[10:11] nt
    v_add_u32 v3, 5120, v3
    v_and_b32 v3, 0x1ffff, v3
    v_dot2_f32_bf16 v93, v120, v16, 0
    v_dot2_f32_bf16 v93, v121, v17, v93
    v_dot2_f32_bf16 v93, v122, v18, v93
    v_dot2_f32_bf16 v93, v123, v19, v93
    v_add_f32_dpp v37, v94, v94 row_mirror row_mask:0xf bank_mask:0x3
    s_waitcnt vmcnt(8)
    global_load_dwordx4 v[104:107], v3, s[10:11] nt
    v_add_u32 v3, 5120, v3
    v_and_b32 v3, 0x1ffff, v3
    global_load_dwordx4 a[76:79], v92, s[16:17] offset:1024 nt
    v_add_u32 v92, 5120, v92
    s_call_b64 s[30:31], LtabA
    v_dot2_f32_bf16 v94, v124, v16, 0
    v_dot2_f32_bf16 v94, v125, v17, v94
    v_dot2_f32_bf16 v94, v126, v18, v94
    v_dot2_f32_bf16 v94, v127, v19, v94
    v_add_f32_dpp v38, v93, v93 row_mirror row_mask:0xf bank_mask:0x3
    s_waitcnt vmcnt(8)
    global_load_dwordx4 v[108:111], v3, s[10:11] nt
    v_add_u32 v3, 5120, v3
    v_and_b32 v3, 0x1ffff, v3
    v_dot2_f32_bf16 v93, v128, v16, 0
    v_dot2_f32_bf16 v93, v129, v17, v93
    v_dot2_f32_bf16 v93, v130, v18, v93
    v_dot2_f32_bf16 v93, v131, v19, v93
    v_add_f32_dpp v39, v94, v94 row_mirror row_mask:0xf bank_mask:0x3
    s_waitcnt vmcnt(8)
    global_load_dwordx4 v[112:115], v3, s[10:11] nt
    v_add_u32 v3, 5120, v3
    v_and_b32 v3, 0x1ffff, v3
    global_load_dwordx4 a[80:83], v92, s[16:17] offset:0 nt
    v_dot2_f32_bf16 v94, v132, v16, 0
    v_dot2_f32_bf16 v94, v133, v17, v94
    v_dot2_f32_bf16 v94, v134, v18, v94
    v_dot2_f32_bf16 v94, v135, v19, v94
    v_add_f32_dpp v32, v93, v93 row_mirror row_mask:0xf bank_mask:0xc
    s_waitcnt vmcnt(8)
    global_load_dwordx4 v[116:119], v3, s[10:11] nt
    v_add_u32 v3, 5120, v3
    v_and_b32 v3, 0x1ffff, v3
    s_call_b64 s[30:31], LtabB
    v_dot2_f32_bf16 v93, v136, v16, 0
    v_dot2_f32_bf16 v93, v137, v17, v93
    v_dot2_f32_bf16 v93, v138, v18, v93
    v_dot2_f32_bf16 v93, v139, v19, v93
    v_add_f32_dpp v33, v94, v94 row_mirror row_mask:0xf bank_mask:0xc
    s_waitcnt vmcnt(8)
    global_load_dwordx4 v[120:123], v3, s[10:11] nt
    v_add_u32 v3, 5120, v3
    v_and_b32 v3, 0x1ffff, v3
    global_load_dwordx4 a[84:87], v92, s[16:17] offset:256 nt
    v_dot2_f32_bf16 v94, v140, v16, 0
    v_dot2_f32_bf16 v94, v141, v17, v94
    v_dot2_f32_bf16 v94, v142, v18, v94
    v_dot2_f32_bf16 v94, v143, v19, v94
    v_add_f32_dpp v34, v93, v93 row_mirror row_mask:0xf bank_mask:0xc
    s_waitcnt vmcnt(8)
    global_load_dwordx4 v[124:127], v3, s[10:11] nt
    v_add_u32 v3, 5120, v3
    v_and_b32 v3, 0x1ffff, v3
    v_dot2_f32_bf16 v93, v144, v16, 0
    v_dot2_f32_bf16 v93, v145, v17, v93
    v_dot2_f32_bf16 v93, v146, v18, v93
    v_dot2_f32_bf16 v93, v147, v19, v93
    v_add_f32_dpp v35, v94, v94 row_mirror row_mask:0xf bank_mask:0xc
    s_waitcnt vmcnt(8)
    global_load_dwordx4 v[128:131], v3, s[10:11] nt
    v_add_u32 v3, 5120, v3
    v_and_b32 v3, 0x1ffff, v3
    global_load_dwordx4 a[88:91], v92, s[16:17] offset:512 nt
    s_call_b64 s[30:31], LtabC
    v_dot2_f32_bf16 v94, v148, v16, 0
    v_dot2_f32_bf16 v94, v149, v17, v94
    v_dot2_f32_bf16 v94, v150, v18, v94
    v_dot2_f32_bf16 v94, v151, v19, v94
    v_add_f32_dpp v36, v93, v93 row_mirror row_mask:0xf bank_mask:0xc
    s_waitcnt vmcnt(8)
    global_load_dwordx4 v[132:135], v3, s[10:11] nt
    v_add_u32 v3, 5120, v3
    v_and_b32 v3, 0x1ffff, v3
    v_dot2_f32_bf16 v93, v152, v16, 0
    v_dot2_f32_bf16 v93, v153, v17, v93
    v_dot2_f32_bf16 v93, v154, v18, v93
    v_dot2_f32_bf16 v93, v155, v19, v93
    v_add_f32_dpp v37, v94, v94 row_mirror row_mask:0xf bank_mask:0xc
    s_waitcnt vmcnt(8)
    global_load_dwordx4 v[136:139], v3, s[10:11] nt
    v_add_u32 v3, 5120, v3
    v_and_b32 v3, 0x1ffff, v3
    global_load_dwordx4 a[92:95], v92, s[16:17] offset:768 nt
    v_dot2_f32_bf16 v94, v156, v16, 0
    v_dot2_f32_bf16 v94, v157, v17, v94
    v_dot2_f32_bf16 v94, v158, v18, v94
    v_dot2_f32_bf16 v94, v159, v19, v94
    v_add_f32_dpp v38, v93, v93 row_mirror row_mask:0xf bank_mask:0xc
    s_waitcnt vmcnt(8)
    global_load_dwordx4 v[140:143], v3, s[10:11] nt
    v_add_u32 v3, 5120, v3
    v_and_b32 v3, 0x1ffff, v3
    s_nop 2
    v_add_f32_dpp v39, v94, v94 row_mirror row_mask:0xf bank_mask:0xc
    s_nop 1
    v_add_f32_dpp v40, v32, v32 row_half_mirror row_mask:0xf bank_mask:0x5
    v_add_f32_dpp v40, v36, v36 row_half_mirror row_mask:0xf bank_mask:0xa
    v_add_f32_dpp v41, v33, v33 row_half_mirror row_mask:0xf bank_mask:0x5
    v_add_f32_dpp v41, v37, v37 row_half_mirror row_mask:0xf bank_mask:0xa
    v_add_f32_dpp v42, v34, v34 row_half_mirror row_mask:0xf bank_mask:0x5
    v_add_f32_dpp v42, v38, v38 row_half_mirror row_mask:0xf bank_mask:0xa
    v_add_f32_dpp v43, v35, v35 row_half_mirror row_mask:0xf bank_mask:0x5
    v_add_f32_dpp v43, v39, v39 row_half_mirror row_mask:0xf bank_mask:0xa
    s_nop 0
    v_add_f32_dpp v44, v40, v40 quad_perm:[2,3,0,1] row_mask:0xf bank_mask:0xf
    v_add_f32_dpp v45, v41, v41 quad_perm:[2,3,0,1] row_mask:0xf bank_mask:0xf
    v_add_f32_dpp v46, v42, v42 quad_perm:[2,3,0,1] row_mask:0xf bank_mask:0xf
    v_add_f32_dpp v47, v43, v43 quad_perm:[2,3,0,1] row_mask:0xf bank_mask:0xf
    v_cndmask_b32 v40, v44, v46, s[4:5]
    v_cndmask_b32 v41, v45, v47, s[4:5]
    s_nop 1
    v_add_f32_dpp v42, v40, v40 quad_perm:[1,0,3,2] row_mask:0xf bank_mask:0xf
    v_add_f32_dpp v43, v41, v41 quad_perm:[1,0,3,2] row_mask:0xf bank_mask:0xf
    v_cndmask_b32 v40, v42, v43, s[6:7]
    v_cvt_pk_bf16_f32 v40, 0, v40
    v_mul_f32 v40, 0x3db504f3, v40
    v_cvt_pk_bf16_f32 v25, 0, v40
    v_dot2_f32_bf16 v93, v160, v16, 0
    v_dot2_f32_bf16 v93, v161, v17, v93
    v_dot2_f32_bf16 v93, v162, v18, v93
    v_dot2_f32_bf16 v93, v163, v19, v93
    s_waitcnt vmcnt(8)
    global_load_dwordx4 v[144:147], v3, s[10:11] nt
    v_add_u32 v3, 5120, v3
    v_and_b32 v3, 0x1ffff, v3
    global_load_dwordx4 a[96:99], v92, s[16:17] offset:1024 nt
    v_add_u32 v92, 5120, v92
    v_dot2_f32_bf16 v94, v164, v16, 0
    v_dot2_f32_bf16 v94, v165, v17, v94
    v_dot2_f32_bf16 v94, v166, v18, v94
    v_dot2_f32_bf16 v94, v167, v19, v94
    v_add_f32_dpp v32, v93, v93 row_mirror row_mask:0xf bank_mask:0x3
    s_waitcnt vmcnt(8)
    global_load_dwordx4 v[148:151], v3, s[10:11] nt
    v_add_u32 v3, 5120, v3
    v_and_b32 v3, 0x1ffff, v3
    v_dot2_f32_bf16 v93, v168, v16, 0
    v_dot2_f32_bf16 v93, v169, v17, v93
    v_dot2_f32_bf16 v93, v170, v18, v93
    v_dot2_f32_bf16 v93, v171, v19, v93
    v_add_f32_dpp v33, v94, v94 row_mirror row_mask:0xf bank_mask:0x3
    s_waitcnt vmcnt(8)
    global_load_dwordx4 v[152:155], v3, s[10:11] nt
    v_add_u32 v3, 5120, v3
    v_and_b32 v3, 0x1ffff, v3
    global_load_dwordx4 a[100:103], v92, s[16:17] offset:0 nt
    v_dot2_f32_bf16 v94, v172, v16, 0
    v_dot2_f32_bf16 v94, v173, v17, v94
    v_dot2_f32_bf16 v94, v174, v18, v94
    v_dot2_f32_bf16 v94, v175, v19, v94
    v_add_f32_dpp v34, v93, v93 row_mirror row_mask:0xf bank_mask:0x3
    s_waitcnt vmcnt(8)
    global_load_dwordx4 v[156:159], v3, s[10:11] nt
    v_add_u32 v3, 5120, v3
    v_and_b32 v3, 0x1ffff, v3
    v_dot2_f32_bf16 v93, v96, v16, 0
    v_dot2_f32_bf16 v93, v97, v17, v93
    v_dot2_f32_bf16 v93, v98, v18, v93
    v_dot2_f32_bf16 v93, v99, v19, v93
    v_add_f32_dpp v35, v94, v94 row_mirror row_mask:0xf bank_mask:0x3
    s_waitcnt vmcnt(8)
    global_load_dwordx4 v[160:163], v3, s[10:11] nt
    v_add_u32 v3, 5120, v3
    v_and_b32 v3, 0x1ffff, v3
    global_load_dwordx4 a[104:107], v92, s[16:17] offset:256 nt
    v_dot2_f32_bf16 v94, v100, v16, 0
    v_dot2_f32_bf16 v94, v101, v17, v94
    v_dot2_f32_bf16 v94, v102, v18, v94
    v_dot2_f32_bf16 v94, v103, v19, v94
    v_add_f32_dpp v36, v93, v93 row_mirror row_mask:0xf bank_mask:0x3
    s_waitcnt vmcnt(8)
    global_load_dwordx4 v[164:167], v3, s[10:11] nt
    v_add_u32 v3, 5120, v3
    v_and_b32 v3, 0x1ffff, v3
    v_dot2_f32_bf16 v93, v104, v16, 0
    v_dot2_f32_bf16 v93, v105, v17, v93
    v_dot2_f32_bf16 v93, v106, v18, v93
    v_dot2_f32_bf16 v93, v107, v19, v93
    v_add_f32_dpp v37, v94, v94 row_mirror row_mask:0xf bank_mask:0x3
    s_waitcnt vmcnt(8)
    global_load_dwordx4 v[168:171], v3, s[10:11] nt
    v_add_u32 v3, 5120, v3
    v_and_b32 v3, 0x1ffff, v3
    global_load_dwordx4 a[108:111], v92, s[16:17] offset:512 nt
    v_dot2_f32_bf16 v94, v108, v16, 0
    v_dot2_f32_bf16 v94, v109, v17, v94
    v_dot2_f32_bf16 v94, v110, v18, v94
    v_dot2_f32_bf16 v94, v111, v19, v94
    v_add_f32_dpp v38, v93, v93 row_mirror row_mask:0xf bank_mask:0x3
    s_waitcnt vmcnt(8)
    global_load_dwordx4 v[172:175], v3, s[10:11] nt
    v_add_u32 v3, 5120, v3
    v_and_b32 v3, 0x1ffff, v3
    v_dot2_f32_bf16 v93, v112, v16, 0
    v_dot2_f32_bf16 v93, v113, v17, v93
    v_dot2_f32_bf16 v93, v114, v18, v93
    v_dot2_f32_bf16 v93, v115, v19, v93
    v_add_f32_dpp v39, v94, v94 row_mirror row_mask:0xf bank_mask:0x3
    s_waitcnt vmcnt(8)
    global_load_dwordx4 v[96:99], v3, s[10:11] nt
    v_add_u32 v3, 5120, v3
    v_and_b32 v3, 0x1ffff, v3
    global_load_dwordx4 a[112:115], v92, s[16:17] offset:768 nt
    v_dot2_f32_bf16 v94, v116, v16, 0
    v_dot2_f32_bf16 v94, v117, v17, v94
    v_dot2_f32_bf16 v94, v118, v18, v94
    v_dot2_f32_bf16 v94, v119, v19, v94
    v_add_f32_dpp v32, v93, v93 row_mirror row_mask:0xf bank_mask:0xc
    s_waitcnt vmcnt(8)
    global_load_dwordx4 v[100:103], v3, s[10:11] nt
    v_add_u32 v3, 5120, v3
    v_and_b32 v3, 0x1ffff, v3
    v_dot2_f32_bf16 v93, v120, v16, 0
    v_dot2_f32_bf16 v93, v121, v17, v93
    v_dot2_f32_bf16 v93, v122, v18, v93
    v_dot2_f32_bf16 v93, v123, v19, v93
    v_add_f32_dpp v33, v94, v94 row_mirror row_mask:0xf bank_mask:0xc
    s_waitcnt vmcnt(8)
    global_load_dwordx4 v[104:107], v3, s[10:11] nt
    v_add_u32 v3, 5120, v3
    v_and_b32 v3, 0x1ffff, v3
    global_load_dwordx4 a[116:119], v92, s[16:17] offset:1024 nt
    v_add_u32 v92, 5120, v92
    v_dot2_f32_bf16 v94, v124, v16, 0
    v_dot2_f32_bf16 v94, v125, v17, v94
    v_dot2_f32_bf16 v94, v126, v18, v94
    v_dot2_f32_bf16 v94, v127, v19, v94
    v_add_f32_dpp v34, v93, v93 row_mirror row_mask:0xf bank_mask:0xc
    s_waitcnt vmcnt(8)
    global_load_dwordx4 v[108:111], v3, s[10:11] nt
    v_add_u32 v3, 5120, v3
    v_and_b32 v3, 0x1ffff, v3
    v_dot2_f32_bf16 v93, v128, v16, 0
    v_dot2_f32_bf16 v93, v129, v17, v93
    v_dot2_f32_bf16 v93, v130, v18, v93
    v_dot2_f32_bf16 v93, v131, v19, v93
    v_add_f32_dpp v35, v94, v94 row_mirror row_mask:0xf bank_mask:0xc
    s_waitcnt vmcnt(8)
    global_load_dwordx4 v[112:115], v3, s[10:11] nt
    v_add_u32 v3, 5120, v3
    v_and_b32 v3, 0x1ffff, v3
    global_load_dwordx4 a[120:123], v92, s[16:17] offset:0 nt
    v_dot2_f32_bf16 v94, v132, v16, 0
    v_dot2_f32_bf16 v94, v133, v17, v94
    v_dot2_f32_bf16 v94, v134, v18, v94
    v_dot2_f32_bf16 v94, v135, v19, v94
    v_add_f32_dpp v36, v93, v93 row_mirror row_mask:0xf bank_mask:0xc
    s_waitcnt vmcnt(8)
    global_load_dwordx4 v[116:119], v3, s[10:11] nt
    v_add_u32 v3, 5120, v3
    v_and_b32 v3, 0x1ffff, v3
    v_dot2_f32_bf16 v93, v136, v16, 0
    v_dot2_f32_bf16 v93, v137, v17, v93
    v_dot2_f32_bf16 v93, v138, v18, v93
    v_dot2_f32_bf16 v93, v139, v19, v93
    v_add_f32_dpp v37, v94, v94 row_mirror row_mask:0xf bank_mask:0xc
    s_waitcnt vmcnt(8)
    global_load_dwordx4 v[120:123], v3, s[10:11] nt
    v_add_u32 v3, 5120, v3
    v_and_b32 v3, 0x1ffff, v3
    global_load_dwordx4 a[124:127], v92, s[16:17] offset:256 nt
    v_dot2_f32_bf16 v94, v140, v16, 0
    v_dot2_f32_bf16 v94, v141, v17, v94
    v_dot2_f32_bf16 v94, v142, v18, v94
    v_dot2_f32_bf16 v94, v143, v19, v94
    v_add_f32_dpp v38, v93, v93 row_mirror row_mask:0xf bank_mask:0xc
    s_waitcnt vmcnt(8)
    global_load_dwordx4 v[124:127], v3, s[10:11] nt
    v_add_u32 v3, 5120, v3
    v_and_b32 v3, 0x1ffff, v3
    s_nop 2
    v_add_f32_dpp v39, v94, v94 row_mirror row_mask:0xf bank_mask:0xc
    s_nop 1
    v_add_f32_dpp v40, v32, v32 row_half_mirror row_mask:0xf bank_mask:0x5
    v_add_f32_dpp v40, v36, v36 row_half_mirror row_mask:0xf bank_mask:0xa
    v_add_f32_dpp v41, v33, v33 row_half_mirror row_mask:0xf bank_mask:0x5
    v_add_f32_dpp v41, v37, v37 row_half_mirror row_mask:0xf bank_mask:0xa
    v_add_f32_dpp v42, v34, v34 row_half_mirror row_mask:0xf bank_mask:0x5
    v_add_f32_dpp v42, v38, v38 row_half_mirror row_mask:0xf bank_mask:0xa
    v_add_f32_dpp v43, v35, v35 row_half_mirror row_mask:0xf bank_mask:0x5
    v_add_f32_dpp v43, v39, v39 row_half_mirror row_mask:0xf bank_mask:0xa
    s_nop 0
    v_add_f32_dpp v44, v40, v40 quad_perm:[2,3,0,1] row_mask:0xf bank_mask:0xf
    v_add_f32_dpp v45, v41, v41 quad_perm:[2,3,0,1] row_mask:0xf bank_mask:0xf
    v_add_f32_dpp v46, v42, v42 quad_perm:[2,3,0,1] row_mask:0xf bank_mask:0xf
    v_add_f32_dpp v47, v43, v43 quad_perm:[2,3,0,1] row_mask:0xf bank_mask:0xf
    v_cndmask_b32 v40, v44, v46, s[4:5]
    v_cndmask_b32 v41, v45, v47, s[4:5]
    s_nop 1
    v_add_f32_dpp v42, v40, v40 quad_perm:[1,0,3,2] row_mask:0xf bank_mask:0xf
    v_add_f32_dpp v43, v41, v41 quad_perm:[1,0,3,2] row_mask:0xf bank_mask:0xf
    v_cndmask_b32 v40, v42, v43, s[6:7]
    v_cvt_pk_bf16_f32 v40, 0, v40
    v_mul_f32 v40, 0x3db504f3, v40
    v_cvt_pk_bf16_f32 v26, 0, v40
    v_dot2_f32_bf16 v93, v144, v16, 0
    v_dot2_f32_bf16 v93, v145, v17, v93
    v_dot2_f32_bf16 v93, v146, v18, v93
    v_dot2_f32_bf16 v93, v147, v19, v93
    s_waitcnt vmcnt(8)
    global_load_dwordx4 v[128:131], v3, s[12:13] nt
    v_add_u32 v3, 5120, v3
    v_and_b32 v3, 0x1ffff, v3
    global_load_dwordx4 a[128:131], v92, s[16:17] offset:512 nt
    v_dot2_f32_bf16 v94, v148, v16, 0
    v_dot2_f32_bf16 v94, v149, v17, v94
    v_dot2_f32_bf16 v94, v150, v18, v94
    v_dot2_f32_bf16 v94, v151, v19, v94
    v_add_f32_dpp v32, v93, v93 row_mirror row_mask:0xf bank_mask:0x3
    s_waitcnt vmcnt(8)
    global_load_dwordx4 v[132:135], v3, s[12:13] nt
    v_add_u32 v3, 5120, v3
    v_and_b32 v3, 0x1ffff, v3
    v_dot2_f32_bf16 v93, v152, v16, 0
    v_dot2_f32_bf16 v93, v153, v17, v93
    v_dot2_f32_bf16 v93, v154, v18, v93
    v_dot2_f32_bf16 v93, v155, v19, v93
    v_add_f32_dpp v33, v94, v94 row_mirror row_mask:0xf bank_mask:0x3
    s_waitcnt vmcnt(8)
    global_load_dwordx4 v[136:139], v3, s[12:13] nt
    v_add_u32 v3, 5120, v3
    v_and_b32 v3, 0x1ffff, v3
    global_load_dwordx4 a[132:135], v92, s[16:17] offset:768 nt
    v_dot2_f32_bf16 v94, v156, v16, 0
    v_dot2_f32_bf16 v94, v157, v17, v94
    v_dot2_f32_bf16 v94, v158, v18, v94
    v_dot2_f32_bf16 v94, v159, v19, v94
    v_add_f32_dpp v34, v93, v93 row_mirror row_mask:0xf bank_mask:0x3
    s_waitcnt vmcnt(8)
    global_load_dwordx4 v[140:143], v3, s[12:13] nt
    v_add_u32 v3, 5120, v3
    v_and_b32 v3, 0x1ffff, v3
    v_dot2_f32_bf16 v93, v160, v16, 0
    v_dot2_f32_bf16 v93, v161, v17, v93
    v_dot2_f32_bf16 v93, v162, v18, v93
    v_dot2_f32_bf16 v93, v163, v19, v93
    v_add_f32_dpp v35, v94, v94 row_mirror row_mask:0xf bank_mask:0x3
    s_waitcnt vmcnt(8)
    global_load_dwordx4 v[144:147], v3, s[12:13] nt
    v_add_u32 v3, 5120, v3
    v_and_b32 v3, 0x1ffff, v3
    global_load_dwordx4 a[136:139], v92, s[16:17] offset:1024 nt
    v_add_u32 v92, 5120, v92
    v_dot2_f32_bf16 v94, v164, v16, 0
    v_dot2_f32_bf16 v94, v165, v17, v94
    v_dot2_f32_bf16 v94, v166, v18, v94
    v_dot2_f32_bf16 v94, v167, v19, v94
    v_add_f32_dpp v36, v93, v93 row_mirror row_mask:0xf bank_mask:0x3
    s_waitcnt vmcnt(8)
    global_load_dwordx4 v[148:151], v3, s[12:13] nt
    v_add_u32 v3, 5120, v3
    v_and_b32 v3, 0x1ffff, v3
    v_dot2_f32_bf16 v93, v168, v16, 0
    v_dot2_f32_bf16 v93, v169, v17, v93
    v_dot2_f32_bf16 v93, v170, v18, v93
    v_dot2_f32_bf16 v93, v171, v19, v93
    v_add_f32_dpp v37, v94, v94 row_mirror row_mask:0xf bank_mask:0x3
    s_waitcnt vmcnt(8)
    global_load_dwordx4 v[152:155], v3, s[12:13] nt
    v_add_u32 v3, 5120, v3
    v_and_b32 v3, 0x1ffff, v3
    global_load_dwordx4 a[140:143], v92, s[16:17] offset:0 nt
    v_dot2_f32_bf16 v94, v172, v16, 0
    v_dot2_f32_bf16 v94, v173, v17, v94
    v_dot2_f32_bf16 v94, v174, v18, v94
    v_dot2_f32_bf16 v94, v175, v19, v94
    v_add_f32_dpp v38, v93, v93 row_mirror row_mask:0xf bank_mask:0x3
    s_waitcnt vmcnt(8)
    global_load_dwordx4 v[156:159], v3, s[12:13] nt
    v_add_u32 v3, 5120, v3
    v_and_b32 v3, 0x1ffff, v3
    v_dot2_f32_bf16 v93, v96, v16, 0
    v_dot2_f32_bf16 v93, v97, v17, v93
    v_dot2_f32_bf16 v93, v98, v18, v93
    v_dot2_f32_bf16 v93, v99, v19, v93
    v_add_f32_dpp v39, v94, v94 row_mirror row_mask:0xf bank_mask:0x3
    s_waitcnt vmcnt(6)
    global_load_dwordx4 v[160:163], v3, s[12:13] nt
    v_add_u32 v3, 5120, v3
    v_and_b32 v3, 0x1ffff, v3
    global_load_dwordx4 a[144:147], v92, s[16:17] offset:256 nt
    v_dot2_f32_bf16 v94, v100, v16, 0
    v_dot2_f32_bf16 v94, v101, v17, v94
    v_dot2_f32_bf16 v94, v102, v18, v94
    v_dot2_f32_bf16 v94, v103, v19, v94
    v_add_f32_dpp v32, v93, v93 row_mirror row_mask:0xf bank_mask:0xc
    s_waitcnt vmcnt(7)
    global_load_dwordx4 v[164:167], v3, s[12:13] nt
    v_add_u32 v3, 5120, v3
    v_and_b32 v3, 0x1ffff, v3
    v_dot2_f32_bf16 v93, v104, v16, 0
    v_dot2_f32_bf16 v93, v105, v17, v93
    v_dot2_f32_bf16 v93, v106, v18, v93
    v_dot2_f32_bf16 v93, v107, v19, v93
    v_add_f32_dpp v33, v94, v94 row_mirror row_mask:0xf bank_mask:0xc
    s_waitcnt vmcnt(6)
    global_load_dwordx4 v[168:171], v3, s[12:13] nt
    v_add_u32 v3, 5120, v3
    v_and_b32 v3, 0x1ffff, v3
    global_load_dwordx4 a[148:151], v92, s[16:17] offset:512 nt
    v_dot2_f32_bf16 v94, v108, v16, 0
    v_dot2_f32_bf16 v94, v109, v17, v94
    v_dot2_f32_bf16 v94, v110, v18, v94
    v_dot2_f32_bf16 v94, v111, v19, v94
    v_add_f32_dpp v34, v93, v93 row_mirror row_mask:0xf bank_mask:0xc
    s_waitcnt vmcnt(7)
    global_load_dwordx4 v[172:175], v3, s[12:13] nt
    v_add_u32 v3, 5120, v3
    v_and_b32 v3, 0x1ffff, v3
    v_dot2_f32_bf16 v93, v112, v16, 0
    v_dot2_f32_bf16 v93, v113, v17, v93
    v_dot2_f32_bf16 v93, v114, v18, v93
    v_dot2_f32_bf16 v93, v115, v19, v93
    v_add_f32_dpp v35, v94, v94 row_mirror row_mask:0xf bank_mask:0xc
    s_waitcnt vmcnt(6)
    global_load_dwordx4 v[96:99], v3, s[12:13] nt
    v_add_u32 v3, 5120, v3
    v_and_b32 v3, 0x1ffff, v3
    global_load_dwordx4 a[152:155], v92, s[16:17] offset:768 nt
    v_dot2_f32_bf16 v94, v116, v16, 0
    v_dot2_f32_bf16 v94, v117, v17, v94
    v_dot2_f32_bf16 v94, v118, v18, v94
    v_dot2_f32_bf16 v94, v119, v19, v94
    v_add_f32_dpp v36, v93, v93 row_mirror row_mask:0xf bank_mask:0xc
    s_waitcnt vmcnt(7)
    global_load_dwordx4 v[100:103], v3, s[12:13] nt
    v_add_u32 v3, 5120, v3
    v_and_b32 v3, 0x1ffff, v3
    v_dot2_f32_bf16 v93, v120, v16, 0
    v_dot2_f32_bf16 v93, v121, v17, v93
    v_dot2_f32_bf16 v93, v122, v18, v93
    v_dot2_f32_bf16 v93, v123, v19, v93
    v_add_f32_dpp v37, v94, v94 row_mirror row_mask:0xf bank_mask:0xc
    s_waitcnt vmcnt(6)
    global_load_dwordx4 v[104:107], v3, s[12:13] nt
    v_add_u32 v3, 5120, v3
    v_and_b32 v3, 0x1ffff, v3
    global_load_dwordx4 a[156:159], v92, s[16:17] offset:1024 nt
    v_add_u32 v92, 5120, v92
    v_dot2_f32_bf16 v94, v124, v16, 0
    v_dot2_f32_bf16 v94, v125, v17, v94
    v_dot2_f32_bf16 v94, v126, v18, v94
    v_dot2_f32_bf16 v94, v127, v19, v94
    v_add_f32_dpp v38, v93, v93 row_mirror row_mask:0xf bank_mask:0xc
    s_waitcnt vmcnt(7)
    global_load_dwordx4 v[108:111], v3, s[12:13] nt
    v_add_u32 v3, 5120, v3
    v_and_b32 v3, 0x1ffff, v3
    global_load_dwordx4 v[112:115], v3, s[12:13] nt
    v_add_u32 v3, 5120, v3
    v_and_b32 v3, 0x1ffff, v3
    global_load_dwordx4 v[116:119], v3, s[12:13] nt
    v_add_u32 v3, 5120, v3
    v_and_b32 v3, 0x1ffff, v3
    global_load_dwordx4 v[120:123], v3, s[12:13] nt
    v_add_u32 v3, 5120, v3
    v_and_b32 v3, 0x1ffff, v3
    global_load_dwordx4 v[124:127], v3, s[12:13] nt
    v_add_u32 v3, 5120, v3
    v_and_b32 v3, 0x1ffff, v3
    s_nop 2
    v_add_f32_dpp v39, v94, v94 row_mirror row_mask:0xf bank_mask:0xc
    s_nop 1
    v_add_f32_dpp v40, v32, v32 row_half_mirror row_mask:0xf bank_mask:0x5
    v_add_f32_dpp v40, v36, v36 row_half_mirror row_mask:0xf bank_mask:0xa
    v_add_f32_dpp v41, v33, v33 row_half_mirror row_mask:0xf bank_mask:0x5
    v_add_f32_dpp v41, v37, v37 row_half_mirror row_mask:0xf bank_mask:0xa
    v_add_f32_dpp v42, v34, v34 row_half_mirror row_mask:0xf bank_mask:0x5
    v_add_f32_dpp v42, v38, v38 row_half_mirror row_mask:0xf bank_mask:0xa
    v_add_f32_dpp v43, v35, v35 row_half_mirror row_mask:0xf bank_mask:0x5
    v_add_f32_dpp v43, v39, v39 row_half_mirror row_mask:0xf bank_mask:0xa
    s_nop 0
    v_add_f32_dpp v44, v40, v40 quad_perm:[2,3,0,1] row_mask:0xf bank_mask:0xf
    v_add_f32_dpp v45, v41, v41 quad_perm:[2,3,0,1] row_mask:0xf bank_mask:0xf
    v_add_f32_dpp v46, v42, v42 quad_perm:[2,3,0,1] row_mask:0xf bank_mask:0xf
    v_add_f32_dpp v47, v43, v43 quad_perm:[2,3,0,1] row_mask:0xf bank_mask:0xf
    v_cndmask_b32 v40, v44, v46, s[4:5]
    v_cndmask_b32 v41, v45, v47, s[4:5]
    s_nop 1
    v_add_f32_dpp v42, v40, v40 quad_perm:[1,0,3,2] row_mask:0xf bank_mask:0xf
    v_add_f32_dpp v43, v41, v41 quad_perm:[1,0,3,2] row_mask:0xf bank_mask:0xf
    v_cndmask_b32 v40, v42, v43, s[6:7]
    v_cvt_pk_bf16_f32 v40, 0, v40
    v_mul_f32 v40, 0x3db504f3, v40
    v_cvt_pk_bf16_f32 v27, 0, v40
    v_max3_f32 v40, v20, v21, v22
    v_max3_f32 v41, v23, v24, v25
    v_max3_f32 v40, v26, v27, v40
    v_max_f32 v40, v40, v41
    s_nop 1
    v_max_f32_dpp v40, v40, v40 row_ror:8 row_mask:0xf bank_mask:0xf
    s_nop 1
    v_max_f32_dpp v40, v40, v40 row_ror:4 row_mask:0xf bank_mask:0xf
    s_nop 1
    v_max_f32_dpp v40, v40, v40 row_ror:2 row_mask:0xf bank_mask:0xf
    s_nop 1
    v_max_f32_dpp v40, v40, v40 row_ror:1 row_mask:0xf bank_mask:0xf
    s_nop 1
    v_max_f32_dpp v40, v40, v40 row_bcast:15 row_mask:0xa bank_mask:0xf
    s_nop 1
    v_max_f32_dpp v40, v40, v40 row_bcast:31 row_mask:0xc bank_mask:0xf
    s_nop 1
    v_readlane_b32 s52, v40, 63
    s_nop 1
    v_subrev_f32 v20, s52, v20
    v_subrev_f32 v21, s52, v21
    v_subrev_f32 v22, s52, v22
    v_subrev_f32 v23, s52, v23
    v_subrev_f32 v24, s52, v24
    v_subrev_f32 v25, s52, v25
    v_subrev_f32 v26, s52, v26
    v_subrev_f32 v27, s52, v27
    v_mul_f32 v20, 0x3fb8aa3b, v20
    v_mul_f32 v21, 0x3fb8aa3b, v21
    v_mul_f32 v22, 0x3fb8aa3b, v22
    v_mul_f32 v23, 0x3fb8aa3b, v23
    v_mul_f32 v24, 0x3fb8aa3b, v24
    v_mul_f32 v25, 0x3fb8aa3b, v25
    v_mul_f32 v26, 0x3fb8aa3b, v26
    v_mul_f32 v27, 0x3fb8aa3b, v27
    v_exp_f32 v20, v20
    v_exp_f32 v21, v21
    v_exp_f32 v22, v22
    v_exp_f32 v23, v23
    v_exp_f32 v24, v24
    v_exp_f32 v25, v25
    v_exp_f32 v26, v26
    v_exp_f32 v27, v27
    v_add_f32 v40, v20, v21
    v_add_f32 v41, v22, v23
    v_add_f32 v42, v24, v25
    v_add_f32 v43, v26, v27
    v_add_f32 v40, v40, v41
    v_add_f32 v42, v42, v43
    v_add_f32 v40, v40, v42
    v_cvt_pk_bf16_f32 v20, v20, v20
    v_cvt_pk_bf16_f32 v21, v21, v21
    v_cvt_pk_bf16_f32 v22, v22, v22
    v_cvt_pk_bf16_f32 v23, v23, v23
    v_cvt_pk_bf16_f32 v24, v24, v24
    v_cvt_pk_bf16_f32 v25, v25, v25
    v_cvt_pk_bf16_f32 v26, v26, v26
    v_cvt_pk_bf16_f32 v27, v27, v27
    v_add_f32_dpp v40, v40, v40 row_ror:8 row_mask:0xf bank_mask:0xf
    v_add_f32_dpp v80, v80, v80 row_ror:8 row_mask:0xf bank_mask:0xf
    v_add_f32_dpp v81, v81, v81 row_ror:8 row_mask:0xf bank_mask:0xf
    v_add_f32_dpp v82, v82, v82 row_ror:8 row_mask:0xf bank_mask:0xf
    v_add_f32_dpp v83, v83, v83 row_ror:8 row_mask:0xf bank_mask:0xf
    v_add_f32_dpp v84, v84, v84 row_ror:8 row_mask:0xf bank_mask:0xf
    v_add_f32_dpp v85, v85, v85 row_ror:8 row_mask:0xf bank_mask:0xf
    v_add_f32_dpp v40, v40, v40 row_ror:4 row_mask:0xf bank_mask:0xf
    v_add_f32_dpp v80, v80, v80 row_ror:4 row_mask:0xf bank_mask:0xf
    v_add_f32_dpp v81, v81, v81 row_ror:4 row_mask:0xf bank_mask:0xf
    v_add_f32_dpp v82, v82, v82 row_ror:4 row_mask:0xf bank_mask:0xf
    v_add_f32_dpp v83, v83, v83 row_ror:4 row_mask:0xf bank_mask:0xf
    v_add_f32_dpp v84, v84, v84 row_ror:4 row_mask:0xf bank_mask:0xf
    v_add_f32_dpp v85, v85, v85 row_ror:4 row_mask:0xf bank_mask:0xf
    v_add_f32_dpp v40, v40, v40 row_ror:2 row_mask:0xf bank_mask:0xf
    v_add_f32_dpp v80, v80, v80 row_ror:2 row_mask:0xf bank_mask:0xf
    v_add_f32_dpp v81, v81, v81 row_ror:2 row_mask:0xf bank_mask:0xf
    v_add_f32_dpp v82, v82, v82 row_ror:2 row_mask:0xf bank_mask:0xf
    v_add_f32_dpp v83, v83, v83 row_ror:2 row_mask:0xf bank_mask:0xf
    v_add_f32_dpp v84, v84, v84 row_ror:2 row_mask:0xf bank_mask:0xf
    v_add_f32_dpp v85, v85, v85 row_ror:2 row_mask:0xf bank_mask:0xf
    v_add_f32_dpp v40, v40, v40 row_ror:1 row_mask:0xf bank_mask:0xf
    v_add_f32_dpp v80, v80, v80 row_ror:1 row_mask:0xf bank_mask:0xf
    v_add_f32_dpp v81, v81, v81 row_ror:1 row_mask:0xf bank_mask:0xf
    v_add_f32_dpp v82, v82, v82 row_ror:1 row_mask:0xf bank_mask:0xf
    v_add_f32_dpp v83, v83, v83 row_ror:1 row_mask:0xf bank_mask:0xf
    v_add_f32_dpp v84, v84, v84 row_ror:1 row_mask:0xf bank_mask:0xf
    v_add_f32_dpp v85, v85, v85 row_ror:1 row_mask:0xf bank_mask:0xf
    v_add_f32_dpp v40, v40, v40 row_bcast:15 row_mask:0xa bank_mask:0xf
    v_add_f32_dpp v80, v80, v80 row_bcast:15 row_mask:0xa bank_mask:0xf
    v_add_f32_dpp v81, v81, v81 row_bcast:15 row_mask:0xa bank_mask:0xf
    v_add_f32_dpp v82, v82, v82 row_bcast:15 row_mask:0xa bank_mask:0xf
    v_add_f32_dpp v83, v83, v83 row_bcast:15 row_mask:0xa bank_mask:0xf
    v_add_f32_dpp v84, v84, v84 row_bcast:15 row_mask:0xa bank_mask:0xf
    v_add_f32_dpp v85, v85, v85 row_bcast:15 row_mask:0xa bank_mask:0xf
    v_add_f32_dpp v40, v40, v40 row_bcast:31 row_mask:0xc bank_mask:0xf
    v_add_f32_dpp v80, v80, v80 row_bcast:31 row_mask:0xc bank_mask:0xf
    v_add_f32_dpp v81, v81, v81 row_bcast:31 row_mask:0xc bank_mask:0xf
    v_add_f32_dpp v82, v82, v82 row_bcast:31 row_mask:0xc bank_mask:0xf
    v_add_f32_dpp v83, v83, v83 row_bcast:31 row_mask:0xc bank_mask:0xf
    v_add_f32_dpp v84, v84, v84 row_bcast:31 row_mask:0xc bank_mask:0xf
    v_add_f32_dpp v85, v85, v85 row_bcast:31 row_mask:0xc bank_mask:0xf
    v_mov_b32 v44, s52
    v_mov_b32 v45, s38
    v_mov_b32 v46, v40
    v_mov_b32 v47, s38
    v_cvt_pk_bf16_f32 v80, 0, v80
    v_cvt_pk_bf16_f32 v81, 0, v81
    v_cvt_pk_bf16_f32 v82, 0, v82
    v_add_f32 v80, v80, v87
    v_add_f32 v81, v81, v87
    v_add_f32 v82, v82, v87
    v_cvt_pk_bf16_f32 v48, v80, v81
    v_cvt_pk_bf16_f32 v50, v82, v82
    v_cvt_pk_bf16_f32 v83, 0, v83
    v_cvt_pk_bf16_f32 v84, 0, v84
    v_cvt_pk_bf16_f32 v85, 0, v85
    v_add_f32 v83, v83, v87
    v_add_f32 v84, v84, v87
    v_add_f32 v85, v85, v87
    v_cvt_pk_bf16_f32 v52, v83, v84
    v_cvt_pk_bf16_f32 v54, v85, v85
    v_mov_b32 v49, s38
    v_mov_b32 v51, s38
    v_mov_b32 v53, s38
    v_mov_b32 v55, s38
    s_lshl_b32 s55, s34, 4
    v_mov_b32 v40, s55
    v_lshlrev_b32 v41, 1, v40
    v_mov_b32 v42, 1
    v_mov_b32 v43, 0
    s_mov_b32 exec_lo, 0
    s_mov_b32 exec_hi, 0x80000000
    ds_write_b128 v40, v[44:47] offset:53504
    ds_write_b128 v41, v[48:51] offset:53568
    ds_write_b128 v41, v[52:55] offset:53584
    s_waitcnt lgkmcnt(0)
    ds_add_rtn_u32 v42, v43, v42 offset:53760
    s_mov_b64 exec, -1
    s_waitcnt lgkmcnt(0)
    v_readlane_b32 s55, v42, 63
    s_nop 3
    s_cmp_lg_u32 s55, 3
    s_cbranch_scc1 Lag5
    ds_read_b128 v[44:47], v2 offset:53504
    s_lshl_b32 s55, s54, 6
    s_add_u32 s55, s55, 8192
    s_lshl_b32 s53, s2, 7
    s_add_u32 s53, s53, 65472
    v_mov_b32 v48, s55
    v_mov_b32 v49, s53
    v_cmp_lt_u32 vcc, 3, v1
    s_nop 1
    v_cndmask_b32 v48, v48, v49, vcc
    v_add_u32 v48, v48, v2
    s_mov_b64 exec, 0xfff
    s_waitcnt lgkmcnt(0)
    global_store_dwordx4 v48, v[44:47], s[32:33] sc1
    s_mov_b64 exec, -1
Lag5:
    s_lshr_b32 s55, s54, 2
    s_lshl_b32 s55, s55, 8
    s_add_u32 s55, s55, 8192
    v_add_u32 v67, s55, v2
    s_lshl_b32 s55, s36, 8
    s_add_u32 s55, s55, 4096
    v_mov_b32 v32, s55
    v_cmp_lt_u32 vcc, 15, v1
    s_nop 1
    v_cndmask_b32 v67, v67, v32, vcc
    s_add_u32 s48, s32, 65536
    s_addc_u32 s49, s33, 0
    s_lshl_b32 s50, s39, 15
    v_lshlrev_b32 v68, 4, v0
    v_min_u32 v69, 213, v0
    v_mul_u32_u24 v69, 6, v69
    s_mul_i32 s55, s36, 1280
    v_add_u32 v69, s55, v69
    v_mov_b32 v91, s55
    s_mov_b32 s44, s8
    s_mov_b32 s45, s9
    s_movk_i32 s46, 2560
    s_cmp_eq_u32 s39, 0
    s_cbranch_scc1 Lxf6
    buffer_load_ushort v88, v69, s[44:47], 0 offen offset:0
    buffer_load_ushort v89, v69, s[44:47], 0 offen offset:2
    buffer_load_ushort v90, v69, s[44:47], 0 offen offset:4
    buffer_load_ushort v91, v91, s[44:47], 0 offen
Lxf6:
    v_and_b32_dpp v12, v20, v4 row_newbcast:0 row_mask:0xf bank_mask:0xf
    v_and_b32_dpp v13, v20, v5 row_newbcast:0 row_mask:0xf bank_mask:0xf
    v_and_b32_dpp v14, v20, v6 row_newbcast:0 row_mask:0xf bank_mask:0xf
    v_and_b32_dpp v15, v20, v7 row_newbcast:0 row_mask:0xf bank_mask:0xf
    s_nop 1
    v_mfma_f32_16x16x32_bf16 v[28:31], v[12:15], v[128:131], 0
    v_and_b32_dpp v8, v20, v4 row_newbcast:1 row_mask:0xf bank_mask:0xf
    v_and_b32_dpp v9, v20, v5 row_newbcast:1 row_mask:0xf bank_mask:0xf
    v_and_b32_dpp v10, v20, v6 row_newbcast:1 row_mask:0xf bank_mask:0xf
    v_and_b32_dpp v11, v20, v7 row_newbcast:1 row_mask:0xf bank_mask:0xf
    s_nop 1
    v_mfma_f32_16x16x32_bf16 v[28:31], v[8:11], v[132:135], v[28:31]
    v_and_b32_dpp v12, v20, v4 row_newbcast:2 row_mask:0xf bank_mask:0xf
    v_and_b32_dpp v13, v20, v5 row_newbcast:2 row_mask:0xf bank_mask:0xf
    v_and_b32_dpp v14, v20, v6 row_newbcast:2 row_mask:0xf bank_mask:0xf
    v_and_b32_dpp v15, v20, v7 row_newbcast:2 row_mask:0xf bank_mask:0xf
    s_nop 1
    v_mfma_f32_16x16x32_bf16 v[28:31], v[12:15], v[136:139], v[28:31]
    v_and_b32_dpp v8, v20, v4 row_newbcast:3 row_mask:0xf bank_mask:0xf
    v_and_b32_dpp v9, v20, v5 row_newbcast:3 row_mask:0xf bank_mask:0xf
    v_and_b32_dpp v10, v20, v6 row_newbcast:3 row_mask:0xf bank_mask:0xf
    v_and_b32_dpp v11, v20, v7 row_newbcast:3 row_mask:0xf bank_mask:0xf
    s_nop 1
    v_mfma_f32_16x16x32_bf16 v[28:31], v[8:11], v[140:143], v[28:31]
    v_and_b32_dpp v12, v20, v4 row_newbcast:4 row_mask:0xf bank_mask:0xf
    v_and_b32_dpp v13, v20, v5 row_newbcast:4 row_mask:0xf bank_mask:0xf
    v_and_b32_dpp v14, v20, v6 row_newbcast:4 row_mask:0xf bank_mask:0xf
    v_and_b32_dpp v15, v20, v7 row_newbcast:4 row_mask:0xf bank_mask:0xf
    s_nop 1
    v_mfma_f32_16x16x32_bf16 v[28:31], v[12:15], v[144:147], v[28:31]
    s_waitcnt vmcnt(4)
    global_load_dwordx4 v[128:131], v3, s[12:13] nt
    v_add_u32 v3, 5120, v3
    v_and_b32 v3, 0x1ffff, v3
    v_and_b32_dpp v8, v20, v4 row_newbcast:5 row_mask:0xf bank_mask:0xf
    v_and_b32_dpp v9, v20, v5 row_newbcast:5 row_mask:0xf bank_mask:0xf
    v_and_b32_dpp v10, v20, v6 row_newbcast:5 row_mask:0xf bank_mask:0xf
    v_and_b32_dpp v11, v20, v7 row_newbcast:5 row_mask:0xf bank_mask:0xf
    s_nop 1
    v_mfma_f32_16x16x32_bf16 v[28:31], v[8:11], v[148:151], v[28:31]
    s_waitcnt vmcnt(4)
    global_load_dwordx4 v[132:135], v3, s[12:13] nt
    v_add_u32 v3, 5120, v3
    v_and_b32 v3, 0x1ffff, v3
    v_and_b32_dpp v12, v20, v4 row_newbcast:6 row_mask:0xf bank_mask:0xf
    v_and_b32_dpp v13, v20, v5 row_newbcast:6 row_mask:0xf bank_mask:0xf
    v_and_b32_dpp v14, v20, v6 row_newbcast:6 row_mask:0xf bank_mask:0xf
    v_and_b32_dpp v15, v20, v7 row_newbcast:6 row_mask:0xf bank_mask:0xf
    s_nop 1
    v_mfma_f32_16x16x32_bf16 v[28:31], v[12:15], v[152:155], v[28:31]
    s_waitcnt vmcnt(4)
    global_load_dwordx4 v[136:139], v3, s[12:13] nt
    v_add_u32 v3, 5120, v3
    v_and_b32 v3, 0x1ffff, v3
    v_and_b32_dpp v8, v20, v4 row_newbcast:7 row_mask:0xf bank_mask:0xf
    v_and_b32_dpp v9, v20, v5 row_newbcast:7 row_mask:0xf bank_mask:0xf
    v_and_b32_dpp v10, v20, v6 row_newbcast:7 row_mask:0xf bank_mask:0xf
    v_and_b32_dpp v11, v20, v7 row_newbcast:7 row_mask:0xf bank_mask:0xf
    s_nop 1
    v_mfma_f32_16x16x32_bf16 v[28:31], v[8:11], v[156:159], v[28:31]
    s_waitcnt vmcnt(4)
    global_load_dwordx4 v[140:143], v3, s[12:13] nt
    v_add_u32 v3, 5120, v3
    v_and_b32 v3, 0x1ffff, v3
    v_and_b32_dpp v12, v20, v4 row_newbcast:8 row_mask:0xf bank_mask:0xf
    v_and_b32_dpp v13, v20, v5 row_newbcast:8 row_mask:0xf bank_mask:0xf
    v_and_b32_dpp v14, v20, v6 row_newbcast:8 row_mask:0xf bank_mask:0xf
    v_and_b32_dpp v15, v20, v7 row_newbcast:8 row_mask:0xf bank_mask:0xf
    s_nop 1
    v_mfma_f32_16x16x32_bf16 v[28:31], v[12:15], v[160:163], v[28:31]
    s_waitcnt vmcnt(4)
    global_load_dwordx4 v[144:147], v3, s[12:13] nt
    v_add_u32 v3, 5120, v3
    v_and_b32 v3, 0x1ffff, v3
    v_and_b32_dpp v8, v20, v4 row_newbcast:9 row_mask:0xf bank_mask:0xf
    v_and_b32_dpp v9, v20, v5 row_newbcast:9 row_mask:0xf bank_mask:0xf
    v_and_b32_dpp v10, v20, v6 row_newbcast:9 row_mask:0xf bank_mask:0xf
    v_and_b32_dpp v11, v20, v7 row_newbcast:9 row_mask:0xf bank_mask:0xf
    s_nop 1
    v_mfma_f32_16x16x32_bf16 v[28:31], v[8:11], v[164:167], v[28:31]
    s_waitcnt vmcnt(4)
    global_load_dwordx4 v[148:151], v3, s[12:13] nt
    v_add_u32 v3, 5120, v3
    v_and_b32 v3, 0x1ffff, v3
    v_and_b32_dpp v12, v20, v4 row_newbcast:10 row_mask:0xf bank_mask:0xf
    v_and_b32_dpp v13, v20, v5 row_newbcast:10 row_mask:0xf bank_mask:0xf
    v_and_b32_dpp v14, v20, v6 row_newbcast:10 row_mask:0xf bank_mask:0xf
    v_and_b32_dpp v15, v20, v7 row_newbcast:10 row_mask:0xf bank_mask:0xf
    s_nop 1
    v_mfma_f32_16x16x32_bf16 v[28:31], v[12:15], v[168:171], v[28:31]
    s_waitcnt vmcnt(4)
    global_load_dwordx4 v[152:155], v3, s[12:13] nt
    v_add_u32 v3, 5120, v3
    v_and_b32 v3, 0x1ffff, v3
    v_and_b32_dpp v8, v20, v4 row_newbcast:11 row_mask:0xf bank_mask:0xf
    v_and_b32_dpp v9, v20, v5 row_newbcast:11 row_mask:0xf bank_mask:0xf
    v_and_b32_dpp v10, v20, v6 row_newbcast:11 row_mask:0xf bank_mask:0xf
    v_and_b32_dpp v11, v20, v7 row_newbcast:11 row_mask:0xf bank_mask:0xf
    s_nop 1
    v_mfma_f32_16x16x32_bf16 v[28:31], v[8:11], v[172:175], v[28:31]
    s_waitcnt vmcnt(4)
    global_load_dwordx4 v[156:159], v3, s[12:13] nt
    v_add_u32 v3, 5120, v3
    v_and_b32 v3, 0x1ffff, v3
    v_and_b32_dpp v12, v20, v4 row_newbcast:12 row_mask:0xf bank_mask:0xf
    v_and_b32_dpp v13, v20, v5 row_newbcast:12 row_mask:0xf bank_mask:0xf
    v_and_b32_dpp v14, v20, v6 row_newbcast:12 row_mask:0xf bank_mask:0xf
    v_and_b32_dpp v15, v20, v7 row_newbcast:12 row_mask:0xf bank_mask:0xf
    s_nop 1
    v_mfma_f32_16x16x32_bf16 v[28:31], v[12:15], v[96:99], v[28:31]
    s_waitcnt vmcnt(4)
    global_load_dwordx4 v[160:163], v3, s[12:13] nt
    v_add_u32 v3, 5120, v3
    v_and_b32 v3, 0x1ffff, v3
    v_and_b32_dpp v8, v20, v4 row_newbcast:13 row_mask:0xf bank_mask:0xf
    v_and_b32_dpp v9, v20, v5 row_newbcast:13 row_mask:0xf bank_mask:0xf
    v_and_b32_dpp v10, v20, v6 row_newbcast:13 row_mask:0xf bank_mask:0xf
    v_and_b32_dpp v11, v20, v7 row_newbcast:13 row_mask:0xf bank_mask:0xf
    s_nop 1
    v_mfma_f32_16x16x32_bf16 v[28:31], v[8:11], v[100:103], v[28:31]
    s_waitcnt vmcnt(4)
    global_load_dwordx4 v[164:167], v3, s[12:13] nt
    v_add_u32 v3, 5120, v3
    v_and_b32 v3, 0x1ffff, v3
    v_and_b32_dpp v12, v20, v4 row_newbcast:14 row_mask:0xf bank_mask:0xf
    v_and_b32_dpp v13, v20, v5 row_newbcast:14 row_mask:0xf bank_mask:0xf
    v_and_b32_dpp v14, v20, v6 row_newbcast:14 row_mask:0xf bank_mask:0xf
    v_and_b32_dpp v15, v20, v7 row_newbcast:14 row_mask:0xf bank_mask:0xf
    s_nop 1
    v_mfma_f32_16x16x32_bf16 v[28:31], v[12:15], v[104:107], v[28:31]
    s_waitcnt vmcnt(4)
    global_load_dwordx4 v[168:171], v3, s[12:13] nt
    v_add_u32 v3, 5120, v3
    v_and_b32 v3, 0x1ffff, v3
    v_and_b32_dpp v8, v20, v4 row_newbcast:15 row_mask:0xf bank_mask:0xf
    v_and_b32_dpp v9, v20, v5 row_newbcast:15 row_mask:0xf bank_mask:0xf
    v_and_b32_dpp v10, v20, v6 row_newbcast:15 row_mask:0xf bank_mask:0xf
    v_and_b32_dpp v11, v20, v7 row_newbcast:15 row_mask:0xf bank_mask:0xf
    s_nop 1
    v_mfma_f32_16x16x32_bf16 v[28:31], v[8:11], v[108:111], v[28:31]
    s_waitcnt vmcnt(4)
    global_load_dwordx4 v[172:175], v3, s[12:13] nt
    v_add_u32 v3, 5120, v3
    v_and_b32 v3, 0x1ffff, v3
    v_and_b32_dpp v12, v21, v4 row_newbcast:0 row_mask:0xf bank_mask:0xf
    v_and_b32_dpp v13, v21, v5 row_newbcast:0 row_mask:0xf bank_mask:0xf
    v_and_b32_dpp v14, v21, v6 row_newbcast:0 row_mask:0xf bank_mask:0xf
    v_and_b32_dpp v15, v21, v7 row_newbcast:0 row_mask:0xf bank_mask:0xf
    s_nop 1
    v_mfma_f32_16x16x32_bf16 v[28:31], v[12:15], v[112:115], v[28:31]
    s_waitcnt vmcnt(4)
    global_load_dwordx4 v[96:99], v3, s[12:13] nt
    v_add_u32 v3, 5120, v3
    v_and_b32 v3, 0x1ffff, v3
    v_and_b32_dpp v8, v21, v4 row_newbcast:1 row_mask:0xf bank_mask:0xf
    v_and_b32_dpp v9, v21, v5 row_newbcast:1 row_mask:0xf bank_mask:0xf
    v_and_b32_dpp v10, v21, v6 row_newbcast:1 row_mask:0xf bank_mask:0xf
    v_and_b32_dpp v11, v21, v7 row_newbcast:1 row_mask:0xf bank_mask:0xf
    s_nop 1
    v_mfma_f32_16x16x32_bf16 v[28:31], v[8:11], v[116:119], v[28:31]
    s_waitcnt vmcnt(4)
    global_load_dwordx4 v[100:103], v3, s[12:13] nt
    v_add_u32 v3, 5120, v3
    v_and_b32 v3, 0x1ffff, v3
    v_and_b32_dpp v12, v21, v4 row_newbcast:2 row_mask:0xf bank_mask:0xf
    v_and_b32_dpp v13, v21, v5 row_newbcast:2 row_mask:0xf bank_mask:0xf
    v_and_b32_dpp v14, v21, v6 row_newbcast:2 row_mask:0xf bank_mask:0xf
    v_and_b32_dpp v15, v21, v7 row_newbcast:2 row_mask:0xf bank_mask:0xf
    s_nop 1
    v_mfma_f32_16x16x32_bf16 v[28:31], v[12:15], v[120:123], v[28:31]
    s_waitcnt vmcnt(4)
    global_load_dwordx4 v[104:107], v3, s[12:13] nt
    v_add_u32 v3, 5120, v3
    v_and_b32 v3, 0x1ffff, v3
    v_and_b32_dpp v8, v21, v4 row_newbcast:3 row_mask:0xf bank_mask:0xf
    v_and_b32_dpp v9, v21, v5 row_newbcast:3 row_mask:0xf bank_mask:0xf
    v_and_b32_dpp v10, v21, v6 row_newbcast:3 row_mask:0xf bank_mask:0xf
    v_and_b32_dpp v11, v21, v7 row_newbcast:3 row_mask:0xf bank_mask:0xf
    s_nop 1
    v_mfma_f32_16x16x32_bf16 v[28:31], v[8:11], v[124:127], v[28:31]
    s_waitcnt vmcnt(4)
    global_load_dwordx4 v[108:111], v3, s[12:13] nt
    v_add_u32 v3, 5120, v3
    v_and_b32 v3, 0x1ffff, v3
    v_and_b32_dpp v12, v21, v4 row_newbcast:4 row_mask:0xf bank_mask:0xf
    v_and_b32_dpp v13, v21, v5 row_newbcast:4 row_mask:0xf bank_mask:0xf
    v_and_b32_dpp v14, v21, v6 row_newbcast:4 row_mask:0xf bank_mask:0xf
    v_and_b32_dpp v15, v21, v7 row_newbcast:4 row_mask:0xf bank_mask:0xf
    s_nop 1
    v_mfma_f32_16x16x32_bf16 v[28:31], v[12:15], v[128:131], v[28:31]
    s_waitcnt vmcnt(4)
    global_load_dwordx4 v[112:115], v3, s[12:13] nt
    v_add_u32 v3, 5120, v3
    v_and_b32 v3, 0x1ffff, v3
    v_and_b32_dpp v8, v21, v4 row_newbcast:5 row_mask:0xf bank_mask:0xf
    v_and_b32_dpp v9, v21, v5 row_newbcast:5 row_mask:0xf bank_mask:0xf
    v_and_b32_dpp v10, v21, v6 row_newbcast:5 row_mask:0xf bank_mask:0xf
    v_and_b32_dpp v11, v21, v7 row_newbcast:5 row_mask:0xf bank_mask:0xf
    s_nop 1
    v_mfma_f32_16x16x32_bf16 v[28:31], v[8:11], v[132:135], v[28:31]
    s_waitcnt vmcnt(4)
    global_load_dwordx4 v[116:119], v3, s[12:13] nt
    v_add_u32 v3, 5120, v3
    v_and_b32 v3, 0x1ffff, v3
    v_and_b32_dpp v12, v21, v4 row_newbcast:6 row_mask:0xf bank_mask:0xf
    v_and_b32_dpp v13, v21, v5 row_newbcast:6 row_mask:0xf bank_mask:0xf
    v_and_b32_dpp v14, v21, v6 row_newbcast:6 row_mask:0xf bank_mask:0xf
    v_and_b32_dpp v15, v21, v7 row_newbcast:6 row_mask:0xf bank_mask:0xf
    s_nop 1
    v_mfma_f32_16x16x32_bf16 v[28:31], v[12:15], v[136:139], v[28:31]
    s_waitcnt vmcnt(4)
    global_load_dwordx4 v[120:123], v3, s[12:13] nt
    v_add_u32 v3, 5120, v3
    v_and_b32 v3, 0x1ffff, v3
    v_and_b32_dpp v8, v21, v4 row_newbcast:7 row_mask:0xf bank_mask:0xf
    v_and_b32_dpp v9, v21, v5 row_newbcast:7 row_mask:0xf bank_mask:0xf
    v_and_b32_dpp v10, v21, v6 row_newbcast:7 row_mask:0xf bank_mask:0xf
    v_and_b32_dpp v11, v21, v7 row_newbcast:7 row_mask:0xf bank_mask:0xf
    s_nop 1
    v_mfma_f32_16x16x32_bf16 v[28:31], v[8:11], v[140:143], v[28:31]
    s_waitcnt vmcnt(4)
    global_load_dwordx4 v[124:127], v3, s[12:13] nt
    v_add_u32 v3, 5120, v3
    v_and_b32 v3, 0x1ffff, v3
    v_and_b32_dpp v12, v21, v4 row_newbcast:8 row_mask:0xf bank_mask:0xf
    v_and_b32_dpp v13, v21, v5 row_newbcast:8 row_mask:0xf bank_mask:0xf
    v_and_b32_dpp v14, v21, v6 row_newbcast:8 row_mask:0xf bank_mask:0xf
    v_and_b32_dpp v15, v21, v7 row_newbcast:8 row_mask:0xf bank_mask:0xf
    s_nop 1
    v_mfma_f32_16x16x32_bf16 v[28:31], v[12:15], v[144:147], v[28:31]
    s_waitcnt vmcnt(4)
    global_load_dwordx4 v[128:131], v3, s[12:13] nt
    v_add_u32 v3, 5120, v3
    v_and_b32 v3, 0x1ffff, v3
    v_and_b32_dpp v8, v21, v4 row_newbcast:9 row_mask:0xf bank_mask:0xf
    v_and_b32_dpp v9, v21, v5 row_newbcast:9 row_mask:0xf bank_mask:0xf
    v_and_b32_dpp v10, v21, v6 row_newbcast:9 row_mask:0xf bank_mask:0xf
    v_and_b32_dpp v11, v21, v7 row_newbcast:9 row_mask:0xf bank_mask:0xf
    s_nop 1
    v_mfma_f32_16x16x32_bf16 v[28:31], v[8:11], v[148:151], v[28:31]
    s_waitcnt vmcnt(4)
    global_load_dwordx4 v[132:135], v3, s[12:13] nt
    v_add_u32 v3, 5120, v3
    v_and_b32 v3, 0x1ffff, v3
    v_and_b32_dpp v12, v21, v4 row_newbcast:10 row_mask:0xf bank_mask:0xf
    v_and_b32_dpp v13, v21, v5 row_newbcast:10 row_mask:0xf bank_mask:0xf
    v_and_b32_dpp v14, v21, v6 row_newbcast:10 row_mask:0xf bank_mask:0xf
    v_and_b32_dpp v15, v21, v7 row_newbcast:10 row_mask:0xf bank_mask:0xf
    s_nop 1
    v_mfma_f32_16x16x32_bf16 v[28:31], v[12:15], v[152:155], v[28:31]
    s_waitcnt vmcnt(4)
    global_load_dwordx4 v[136:139], v3, s[12:13] nt
    v_add_u32 v3, 5120, v3
    v_and_b32 v3, 0x1ffff, v3
    v_and_b32_dpp v8, v21, v4 row_newbcast:11 row_mask:0xf bank_mask:0xf
    v_and_b32_dpp v9, v21, v5 row_newbcast:11 row_mask:0xf bank_mask:0xf
    v_and_b32_dpp v10, v21, v6 row_newbcast:11 row_mask:0xf bank_mask:0xf
    v_and_b32_dpp v11, v21, v7 row_newbcast:11 row_mask:0xf bank_mask:0xf
    s_nop 1
    v_mfma_f32_16x16x32_bf16 v[28:31], v[8:11], v[156:159], v[28:31]
    s_waitcnt vmcnt(4)
    global_load_dwordx4 v[140:143], v3, s[12:13] nt
    v_add_u32 v3, 5120, v3
    v_and_b32 v3, 0x1ffff, v3
    v_and_b32_dpp v12, v21, v4 row_newbcast:12 row_mask:0xf bank_mask:0xf
    v_and_b32_dpp v13, v21, v5 row_newbcast:12 row_mask:0xf bank_mask:0xf
    v_and_b32_dpp v14, v21, v6 row_newbcast:12 row_mask:0xf bank_mask:0xf
    v_and_b32_dpp v15, v21, v7 row_newbcast:12 row_mask:0xf bank_mask:0xf
    s_nop 1
    v_mfma_f32_16x16x32_bf16 v[28:31], v[12:15], v[160:163], v[28:31]
    s_waitcnt vmcnt(4)
    global_load_dwordx4 v[144:147], v3, s[12:13] nt
    v_add_u32 v3, 5120, v3
    v_and_b32 v3, 0x1ffff, v3
    v_and_b32_dpp v8, v21, v4 row_newbcast:13 row_mask:0xf bank_mask:0xf
    v_and_b32_dpp v9, v21, v5 row_newbcast:13 row_mask:0xf bank_mask:0xf
    v_and_b32_dpp v10, v21, v6 row_newbcast:13 row_mask:0xf bank_mask:0xf
    v_and_b32_dpp v11, v21, v7 row_newbcast:13 row_mask:0xf bank_mask:0xf
    s_nop 1
    v_mfma_f32_16x16x32_bf16 v[28:31], v[8:11], v[164:167], v[28:31]
    s_waitcnt vmcnt(4)
    global_load_dwordx4 v[148:151], v3, s[12:13] nt
    v_add_u32 v3, 5120, v3
    v_and_b32 v3, 0x1ffff, v3
    v_and_b32_dpp v12, v21, v4 row_newbcast:14 row_mask:0xf bank_mask:0xf
    v_and_b32_dpp v13, v21, v5 row_newbcast:14 row_mask:0xf bank_mask:0xf
    v_and_b32_dpp v14, v21, v6 row_newbcast:14 row_mask:0xf bank_mask:0xf
    v_and_b32_dpp v15, v21, v7 row_newbcast:14 row_mask:0xf bank_mask:0xf
    s_nop 1
    v_mfma_f32_16x16x32_bf16 v[28:31], v[12:15], v[168:171], v[28:31]
    s_waitcnt vmcnt(4)
    global_load_dwordx4 v[152:155], v3, s[12:13] nt
    v_add_u32 v3, 5120, v3
    v_and_b32 v3, 0x1ffff, v3
    v_and_b32_dpp v8, v21, v4 row_newbcast:15 row_mask:0xf bank_mask:0xf
    v_and_b32_dpp v9, v21, v5 row_newbcast:15 row_mask:0xf bank_mask:0xf
    v_and_b32_dpp v10, v21, v6 row_newbcast:15 row_mask:0xf bank_mask:0xf
    v_and_b32_dpp v11, v21, v7 row_newbcast:15 row_mask:0xf bank_mask:0xf
    s_nop 1
    v_mfma_f32_16x16x32_bf16 v[28:31], v[8:11], v[172:175], v[28:31]
    s_waitcnt vmcnt(4)
    global_load_dwordx4 v[156:159], v3, s[12:13] nt
    v_add_u32 v3, 5120, v3
    v_and_b32 v3, 0x1ffff, v3
    v_and_b32_dpp v12, v22, v4 row_newbcast:0 row_mask:0xf bank_mask:0xf
    v_and_b32_dpp v13, v22, v5 row_newbcast:0 row_mask:0xf bank_mask:0xf
    v_and_b32_dpp v14, v22, v6 row_newbcast:0 row_mask:0xf bank_mask:0xf
    v_and_b32_dpp v15, v22, v7 row_newbcast:0 row_mask:0xf bank_mask:0xf
    s_nop 1
    v_mfma_f32_16x16x32_bf16 v[28:31], v[12:15], v[96:99], v[28:31]
    s_waitcnt vmcnt(4)
    global_load_dwordx4 v[160:163], v3, s[12:13] nt
    v_add_u32 v3, 5120, v3
    v_and_b32 v3, 0x1ffff, v3
    v_and_b32_dpp v8, v22, v4 row_newbcast:1 row_mask:0xf bank_mask:0xf
    v_and_b32_dpp v9, v22, v5 row_newbcast:1 row_mask:0xf bank_mask:0xf
    v_and_b32_dpp v10, v22, v6 row_newbcast:1 row_mask:0xf bank_mask:0xf
    v_and_b32_dpp v11, v22, v7 row_newbcast:1 row_mask:0xf bank_mask:0xf
    s_nop 1
    v_mfma_f32_16x16x32_bf16 v[28:31], v[8:11], v[100:103], v[28:31]
    s_waitcnt vmcnt(4)
    global_load_dwordx4 v[164:167], v3, s[12:13] nt
    v_add_u32 v3, 5120, v3
    v_and_b32 v3, 0x1ffff, v3
    v_and_b32_dpp v12, v22, v4 row_newbcast:2 row_mask:0xf bank_mask:0xf
    v_and_b32_dpp v13, v22, v5 row_newbcast:2 row_mask:0xf bank_mask:0xf
    v_and_b32_dpp v14, v22, v6 row_newbcast:2 row_mask:0xf bank_mask:0xf
    v_and_b32_dpp v15, v22, v7 row_newbcast:2 row_mask:0xf bank_mask:0xf
    s_nop 1
    v_mfma_f32_16x16x32_bf16 v[28:31], v[12:15], v[104:107], v[28:31]
    s_waitcnt vmcnt(4)
    global_load_dwordx4 v[168:171], v3, s[12:13] nt
    v_add_u32 v3, 5120, v3
    v_and_b32 v3, 0x1ffff, v3
    v_and_b32_dpp v8, v22, v4 row_newbcast:3 row_mask:0xf bank_mask:0xf
    v_and_b32_dpp v9, v22, v5 row_newbcast:3 row_mask:0xf bank_mask:0xf
    v_and_b32_dpp v10, v22, v6 row_newbcast:3 row_mask:0xf bank_mask:0xf
    v_and_b32_dpp v11, v22, v7 row_newbcast:3 row_mask:0xf bank_mask:0xf
    s_nop 1
    v_mfma_f32_16x16x32_bf16 v[28:31], v[8:11], v[108:111], v[28:31]
    s_waitcnt vmcnt(4)
    global_load_dwordx4 v[172:175], v3, s[12:13] nt
    v_add_u32 v3, 5120, v3
    v_and_b32 v3, 0x1ffff, v3
    v_and_b32_dpp v12, v22, v4 row_newbcast:4 row_mask:0xf bank_mask:0xf
    v_and_b32_dpp v13, v22, v5 row_newbcast:4 row_mask:0xf bank_mask:0xf
    v_and_b32_dpp v14, v22, v6 row_newbcast:4 row_mask:0xf bank_mask:0xf
    v_and_b32_dpp v15, v22, v7 row_newbcast:4 row_mask:0xf bank_mask:0xf
    s_nop 1
    v_mfma_f32_16x16x32_bf16 v[28:31], v[12:15], v[112:115], v[28:31]
    s_waitcnt vmcnt(4)
    global_load_dwordx4 v[96:99], v3, s[12:13] nt
    v_add_u32 v3, 5120, v3
    v_and_b32 v3, 0x1ffff, v3
    v_and_b32_dpp v8, v22, v4 row_newbcast:5 row_mask:0xf bank_mask:0xf
    v_and_b32_dpp v9, v22, v5 row_newbcast:5 row_mask:0xf bank_mask:0xf
    v_and_b32_dpp v10, v22, v6 row_newbcast:5 row_mask:0xf bank_mask:0xf
    v_and_b32_dpp v11, v22, v7 row_newbcast:5 row_mask:0xf bank_mask:0xf
    s_nop 1
    v_mfma_f32_16x16x32_bf16 v[28:31], v[8:11], v[116:119], v[28:31]
    s_waitcnt vmcnt(4)
    global_load_dwordx4 v[100:103], v3, s[12:13] nt
    v_add_u32 v3, 5120, v3
    v_and_b32 v3, 0x1ffff, v3
    v_and_b32_dpp v12, v22, v4 row_newbcast:6 row_mask:0xf bank_mask:0xf
    v_and_b32_dpp v13, v22, v5 row_newbcast:6 row_mask:0xf bank_mask:0xf
    v_and_b32_dpp v14, v22, v6 row_newbcast:6 row_mask:0xf bank_mask:0xf
    v_and_b32_dpp v15, v22, v7 row_newbcast:6 row_mask:0xf bank_mask:0xf
    s_nop 1
    v_mfma_f32_16x16x32_bf16 v[28:31], v[12:15], v[120:123], v[28:31]
    s_waitcnt vmcnt(4)
    global_load_dwordx4 v[104:107], v3, s[12:13] nt
    v_add_u32 v3, 5120, v3
    v_and_b32 v3, 0x1ffff, v3
    v_and_b32_dpp v8, v22, v4 row_newbcast:7 row_mask:0xf bank_mask:0xf
    v_and_b32_dpp v9, v22, v5 row_newbcast:7 row_mask:0xf bank_mask:0xf
    v_and_b32_dpp v10, v22, v6 row_newbcast:7 row_mask:0xf bank_mask:0xf
    v_and_b32_dpp v11, v22, v7 row_newbcast:7 row_mask:0xf bank_mask:0xf
    s_nop 1
    v_mfma_f32_16x16x32_bf16 v[28:31], v[8:11], v[124:127], v[28:31]
    s_waitcnt vmcnt(4)
    global_load_dwordx4 v[108:111], v3, s[12:13] nt
    v_add_u32 v3, 5120, v3
    v_and_b32 v3, 0x1ffff, v3
    v_and_b32_dpp v12, v22, v4 row_newbcast:8 row_mask:0xf bank_mask:0xf
    v_and_b32_dpp v13, v22, v5 row_newbcast:8 row_mask:0xf bank_mask:0xf
    v_and_b32_dpp v14, v22, v6 row_newbcast:8 row_mask:0xf bank_mask:0xf
    v_and_b32_dpp v15, v22, v7 row_newbcast:8 row_mask:0xf bank_mask:0xf
    s_nop 1
    v_mfma_f32_16x16x32_bf16 v[28:31], v[12:15], v[128:131], v[28:31]
    s_waitcnt vmcnt(4)
    global_load_dwordx4 v[112:115], v3, s[12:13] nt
    v_add_u32 v3, 5120, v3
    v_and_b32 v3, 0x1ffff, v3
    v_and_b32_dpp v8, v22, v4 row_newbcast:9 row_mask:0xf bank_mask:0xf
    v_and_b32_dpp v9, v22, v5 row_newbcast:9 row_mask:0xf bank_mask:0xf
    v_and_b32_dpp v10, v22, v6 row_newbcast:9 row_mask:0xf bank_mask:0xf
    v_and_b32_dpp v11, v22, v7 row_newbcast:9 row_mask:0xf bank_mask:0xf
    s_nop 1
    v_mfma_f32_16x16x32_bf16 v[28:31], v[8:11], v[132:135], v[28:31]
    s_waitcnt vmcnt(4)
    global_load_dwordx4 v[116:119], v3, s[12:13] nt
    v_add_u32 v3, 5120, v3
    v_and_b32 v3, 0x1ffff, v3
    v_and_b32_dpp v12, v22, v4 row_newbcast:10 row_mask:0xf bank_mask:0xf
    v_and_b32_dpp v13, v22, v5 row_newbcast:10 row_mask:0xf bank_mask:0xf
    v_and_b32_dpp v14, v22, v6 row_newbcast:10 row_mask:0xf bank_mask:0xf
    v_and_b32_dpp v15, v22, v7 row_newbcast:10 row_mask:0xf bank_mask:0xf
    s_nop 1
    v_mfma_f32_16x16x32_bf16 v[28:31], v[12:15], v[136:139], v[28:31]
    s_waitcnt vmcnt(4)
    global_load_dwordx4 v[120:123], v3, s[12:13] nt
    v_add_u32 v3, 5120, v3
    v_and_b32 v3, 0x1ffff, v3
    v_and_b32_dpp v8, v22, v4 row_newbcast:11 row_mask:0xf bank_mask:0xf
    v_and_b32_dpp v9, v22, v5 row_newbcast:11 row_mask:0xf bank_mask:0xf
    v_and_b32_dpp v10, v22, v6 row_newbcast:11 row_mask:0xf bank_mask:0xf
    v_and_b32_dpp v11, v22, v7 row_newbcast:11 row_mask:0xf bank_mask:0xf
    s_nop 1
    v_mfma_f32_16x16x32_bf16 v[28:31], v[8:11], v[140:143], v[28:31]
    s_waitcnt vmcnt(4)
    global_load_dwordx4 v[124:127], v3, s[12:13] nt
    v_add_u32 v3, 5120, v3
    v_and_b32 v3, 0x1ffff, v3
    v_and_b32_dpp v12, v22, v4 row_newbcast:12 row_mask:0xf bank_mask:0xf
    v_and_b32_dpp v13, v22, v5 row_newbcast:12 row_mask:0xf bank_mask:0xf
    v_and_b32_dpp v14, v22, v6 row_newbcast:12 row_mask:0xf bank_mask:0xf
    v_and_b32_dpp v15, v22, v7 row_newbcast:12 row_mask:0xf bank_mask:0xf
    s_nop 1
    v_mfma_f32_16x16x32_bf16 v[28:31], v[12:15], v[144:147], v[28:31]
    s_waitcnt vmcnt(4)
    global_load_dwordx4 v[128:131], v3, s[12:13] nt
    v_add_u32 v3, 5120, v3
    v_and_b32 v3, 0x1ffff, v3
    v_and_b32_dpp v8, v22, v4 row_newbcast:13 row_mask:0xf bank_mask:0xf
    v_and_b32_dpp v9, v22, v5 row_newbcast:13 row_mask:0xf bank_mask:0xf
    v_and_b32_dpp v10, v22, v6 row_newbcast:13 row_mask:0xf bank_mask:0xf
    v_and_b32_dpp v11, v22, v7 row_newbcast:13 row_mask:0xf bank_mask:0xf
    s_nop 1
    v_mfma_f32_16x16x32_bf16 v[28:31], v[8:11], v[148:151], v[28:31]
    s_waitcnt vmcnt(4)
    global_load_dwordx4 v[132:135], v3, s[12:13] nt
    v_add_u32 v3, 5120, v3
    v_and_b32 v3, 0x1ffff, v3
    v_and_b32_dpp v12, v22, v4 row_newbcast:14 row_mask:0xf bank_mask:0xf
    v_and_b32_dpp v13, v22, v5 row_newbcast:14 row_mask:0xf bank_mask:0xf
    v_and_b32_dpp v14, v22, v6 row_newbcast:14 row_mask:0xf bank_mask:0xf
    v_and_b32_dpp v15, v22, v7 row_newbcast:14 row_mask:0xf bank_mask:0xf
    s_nop 1
    v_mfma_f32_16x16x32_bf16 v[28:31], v[12:15], v[152:155], v[28:31]
    s_waitcnt vmcnt(4)
    global_load_dwordx4 v[136:139], v3, s[12:13] nt
    v_add_u32 v3, 5120, v3
    v_and_b32 v3, 0x1ffff, v3
    v_and_b32_dpp v8, v22, v4 row_newbcast:15 row_mask:0xf bank_mask:0xf
    v_and_b32_dpp v9, v22, v5 row_newbcast:15 row_mask:0xf bank_mask:0xf
    v_and_b32_dpp v10, v22, v6 row_newbcast:15 row_mask:0xf bank_mask:0xf
    v_and_b32_dpp v11, v22, v7 row_newbcast:15 row_mask:0xf bank_mask:0xf
    s_nop 1
    v_mfma_f32_16x16x32_bf16 v[28:31], v[8:11], v[156:159], v[28:31]
    s_waitcnt vmcnt(4)
    global_load_dwordx4 v[140:143], v3, s[12:13] nt
    v_add_u32 v3, 5120, v3
    v_and_b32 v3, 0x1ffff, v3
    v_and_b32_dpp v12, v23, v4 row_newbcast:0 row_mask:0xf bank_mask:0xf
    v_and_b32_dpp v13, v23, v5 row_newbcast:0 row_mask:0xf bank_mask:0xf
    v_and_b32_dpp v14, v23, v6 row_newbcast:0 row_mask:0xf bank_mask:0xf
    v_and_b32_dpp v15, v23, v7 row_newbcast:0 row_mask:0xf bank_mask:0xf
    s_nop 1
    v_mfma_f32_16x16x32_bf16 v[28:31], v[12:15], v[160:163], v[28:31]
    s_waitcnt vmcnt(4)
    global_load_dwordx4 v[144:147], v3, s[12:13] nt
    v_add_u32 v3, 5120, v3
    v_and_b32 v3, 0x1ffff, v3
    s_cmp_eq_u32 s39, 0
    s_cbranch_scc1 Ltl7
    s_movk_i32 s55, 0
    buffer_load_dwordx4 v[176:179], v68, s[48:51], s55 offen sc1
    s_movk_i32 s55, 4096
    buffer_load_dwordx4 v[180:183], v68, s[48:51], s55 offen sc1
    s_movk_i32 s55, 8192
    buffer_load_dwordx4 v[184:187], v68, s[48:51], s55 offen sc1
    s_movk_i32 s55, 12288
    buffer_load_dwordx4 v[188:191], v68, s[48:51], s55 offen sc1
    s_movk_i32 s55, 16384
    buffer_load_dwordx4 v[192:195], v68, s[48:51], s55 offen sc1
    s_movk_i32 s55, 20480
    buffer_load_dwordx4 v[196:199], v68, s[48:51], s55 offen sc1
    s_movk_i32 s55, 24576
    buffer_load_dwordx4 v[200:203], v68, s[48:51], s55 offen sc1
    s_movk_i32 s55, 28672
    buffer_load_dwordx4 v[204:207], v68, s[48:51], s55 offen sc1
Ltl7:
    v_and_b32_dpp v8, v23, v4 row_newbcast:1 row_mask:0xf bank_mask:0xf
    v_and_b32_dpp v9, v23, v5 row_newbcast:1 row_mask:0xf bank_mask:0xf
    v_and_b32_dpp v10, v23, v6 row_newbcast:1 row_mask:0xf bank_mask:0xf
    v_and_b32_dpp v11, v23, v7 row_newbcast:1 row_mask:0xf bank_mask:0xf
    s_nop 1
    v_mfma_f32_16x16x32_bf16 v[28:31], v[8:11], v[164:167], v[28:31]
    s_waitcnt vmcnt(4)
    global_load_dwordx4 v[148:151], v3, s[12:13] nt
    v_add_u32 v3, 5120, v3
    v_and_b32 v3, 0x1ffff, v3
    v_and_b32_dpp v12, v23, v4 row_newbcast:2 row_mask:0xf bank_mask:0xf
    v_and_b32_dpp v13, v23, v5 row_newbcast:2 row_mask:0xf bank_mask:0xf
    v_and_b32_dpp v14, v23, v6 row_newbcast:2 row_mask:0xf bank_mask:0xf
    v_and_b32_dpp v15, v23, v7 row_newbcast:2 row_mask:0xf bank_mask:0xf
    s_nop 1
    v_mfma_f32_16x16x32_bf16 v[28:31], v[12:15], v[168:171], v[28:31]
    s_waitcnt vmcnt(4)
    global_load_dwordx4 v[152:155], v3, s[12:13] nt
    v_add_u32 v3, 5120, v3
    v_and_b32 v3, 0x1ffff, v3
    v_and_b32_dpp v8, v23, v4 row_newbcast:3 row_mask:0xf bank_mask:0xf
    v_and_b32_dpp v9, v23, v5 row_newbcast:3 row_mask:0xf bank_mask:0xf
    v_and_b32_dpp v10, v23, v6 row_newbcast:3 row_mask:0xf bank_mask:0xf
    v_and_b32_dpp v11, v23, v7 row_newbcast:3 row_mask:0xf bank_mask:0xf
    s_nop 1
    v_mfma_f32_16x16x32_bf16 v[28:31], v[8:11], v[172:175], v[28:31]
    s_waitcnt vmcnt(4)
    global_load_dwordx4 v[156:159], v3, s[12:13] nt
    v_add_u32 v3, 5120, v3
    v_and_b32 v3, 0x1ffff, v3
    v_and_b32_dpp v12, v23, v4 row_newbcast:4 row_mask:0xf bank_mask:0xf
    v_and_b32_dpp v13, v23, v5 row_newbcast:4 row_mask:0xf bank_mask:0xf
    v_and_b32_dpp v14, v23, v6 row_newbcast:4 row_mask:0xf bank_mask:0xf
    v_and_b32_dpp v15, v23, v7 row_newbcast:4 row_mask:0xf bank_mask:0xf
    s_nop 1
    v_mfma_f32_16x16x32_bf16 v[28:31], v[12:15], v[96:99], v[28:31]
    s_waitcnt vmcnt(4)
    global_load_dwordx4 v[160:163], v3, s[12:13] nt
    v_add_u32 v3, 5120, v3
    v_and_b32 v3, 0x1ffff, v3
    v_and_b32_dpp v8, v23, v4 row_newbcast:5 row_mask:0xf bank_mask:0xf
    v_and_b32_dpp v9, v23, v5 row_newbcast:5 row_mask:0xf bank_mask:0xf
    v_and_b32_dpp v10, v23, v6 row_newbcast:5 row_mask:0xf bank_mask:0xf
    v_and_b32_dpp v11, v23, v7 row_newbcast:5 row_mask:0xf bank_mask:0xf
    s_nop 1
    v_mfma_f32_16x16x32_bf16 v[28:31], v[8:11], v[100:103], v[28:31]
    s_waitcnt vmcnt(4)
    global_load_dwordx4 v[164:167], v3, s[12:13] nt
    v_add_u32 v3, 5120, v3
    v_and_b32 v3, 0x1ffff, v3
    v_and_b32_dpp v12, v23, v4 row_newbcast:6 row_mask:0xf bank_mask:0xf
    v_and_b32_dpp v13, v23, v5 row_newbcast:6 row_mask:0xf bank_mask:0xf
    v_and_b32_dpp v14, v23, v6 row_newbcast:6 row_mask:0xf bank_mask:0xf
    v_and_b32_dpp v15, v23, v7 row_newbcast:6 row_mask:0xf bank_mask:0xf
    s_nop 1
    v_mfma_f32_16x16x32_bf16 v[28:31], v[12:15], v[104:107], v[28:31]
    s_waitcnt vmcnt(4)
    global_load_dwordx4 v[168:171], v3, s[12:13] nt
    v_add_u32 v3, 5120, v3
    v_and_b32 v3, 0x1ffff, v3
    v_and_b32_dpp v8, v23, v4 row_newbcast:7 row_mask:0xf bank_mask:0xf
    v_and_b32_dpp v9, v23, v5 row_newbcast:7 row_mask:0xf bank_mask:0xf
    v_and_b32_dpp v10, v23, v6 row_newbcast:7 row_mask:0xf bank_mask:0xf
    v_and_b32_dpp v11, v23, v7 row_newbcast:7 row_mask:0xf bank_mask:0xf
    s_nop 1
    v_mfma_f32_16x16x32_bf16 v[28:31], v[8:11], v[108:111], v[28:31]
    s_waitcnt vmcnt(4)
    global_load_dwordx4 v[172:175], v3, s[12:13] nt
    v_add_u32 v3, 5120, v3
    v_and_b32 v3, 0x1ffff, v3
    v_and_b32_dpp v12, v23, v4 row_newbcast:8 row_mask:0xf bank_mask:0xf
    v_and_b32_dpp v13, v23, v5 row_newbcast:8 row_mask:0xf bank_mask:0xf
    v_and_b32_dpp v14, v23, v6 row_newbcast:8 row_mask:0xf bank_mask:0xf
    v_and_b32_dpp v15, v23, v7 row_newbcast:8 row_mask:0xf bank_mask:0xf
    s_nop 1
    v_mfma_f32_16x16x32_bf16 v[28:31], v[12:15], v[112:115], v[28:31]
    s_waitcnt vmcnt(4)
    global_load_dwordx4 v[96:99], v3, s[12:13] nt
    v_add_u32 v3, 5120, v3
    v_and_b32 v3, 0x1ffff, v3
    v_and_b32_dpp v8, v23, v4 row_newbcast:9 row_mask:0xf bank_mask:0xf
    v_and_b32_dpp v9, v23, v5 row_newbcast:9 row_mask:0xf bank_mask:0xf
    v_and_b32_dpp v10, v23, v6 row_newbcast:9 row_mask:0xf bank_mask:0xf
    v_and_b32_dpp v11, v23, v7 row_newbcast:9 row_mask:0xf bank_mask:0xf
    s_nop 1
    v_mfma_f32_16x16x32_bf16 v[28:31], v[8:11], v[116:119], v[28:31]
    s_waitcnt vmcnt(4)
    global_load_dwordx4 v[100:103], v3, s[12:13] nt
    v_add_u32 v3, 5120, v3
    v_and_b32 v3, 0x1ffff, v3
    v_and_b32_dpp v12, v23, v4 row_newbcast:10 row_mask:0xf bank_mask:0xf
    v_and_b32_dpp v13, v23, v5 row_newbcast:10 row_mask:0xf bank_mask:0xf
    v_and_b32_dpp v14, v23, v6 row_newbcast:10 row_mask:0xf bank_mask:0xf
    v_and_b32_dpp v15, v23, v7 row_newbcast:10 row_mask:0xf bank_mask:0xf
    s_nop 1
    v_mfma_f32_16x16x32_bf16 v[28:31], v[12:15], v[120:123], v[28:31]
    s_waitcnt vmcnt(4)
    global_load_dwordx4 v[104:107], v3, s[12:13] nt
    v_add_u32 v3, 5120, v3
    v_and_b32 v3, 0x1ffff, v3
    v_and_b32_dpp v8, v23, v4 row_newbcast:11 row_mask:0xf bank_mask:0xf
    v_and_b32_dpp v9, v23, v5 row_newbcast:11 row_mask:0xf bank_mask:0xf
    v_and_b32_dpp v10, v23, v6 row_newbcast:11 row_mask:0xf bank_mask:0xf
    v_and_b32_dpp v11, v23, v7 row_newbcast:11 row_mask:0xf bank_mask:0xf
    s_nop 1
    v_mfma_f32_16x16x32_bf16 v[28:31], v[8:11], v[124:127], v[28:31]
    s_waitcnt vmcnt(4)
    global_load_dwordx4 v[108:111], v3, s[12:13] nt
    v_add_u32 v3, 5120, v3
    v_and_b32 v3, 0x1ffff, v3
    v_and_b32_dpp v12, v23, v4 row_newbcast:12 row_mask:0xf bank_mask:0xf
    v_and_b32_dpp v13, v23, v5 row_newbcast:12 row_mask:0xf bank_mask:0xf
    v_and_b32_dpp v14, v23, v6 row_newbcast:12 row_mask:0xf bank_mask:0xf
    v_and_b32_dpp v15, v23, v7 row_newbcast:12 row_mask:0xf bank_mask:0xf
    s_nop 1
    v_mfma_f32_16x16x32_bf16 v[28:31], v[12:15], v[128:131], v[28:31]
    s_waitcnt vmcnt(4)
    global_load_dwordx4 v[112:115], v3, s[12:13] nt
    v_add_u32 v3, 5120, v3
    v_and_b32 v3, 0x1ffff, v3
    v_and_b32_dpp v8, v23, v4 row_newbcast:13 row_mask:0xf bank_mask:0xf
    v_and_b32_dpp v9, v23, v5 row_newbcast:13 row_mask:0xf bank_mask:0xf
    v_and_b32_dpp v10, v23, v6 row_newbcast:13 row_mask:0xf bank_mask:0xf
    v_and_b32_dpp v11, v23, v7 row_newbcast:13 row_mask:0xf bank_mask:0xf
    s_nop 1
    v_mfma_f32_16x16x32_bf16 v[28:31], v[8:11], v[132:135], v[28:31]
    s_waitcnt vmcnt(4)
    global_load_dwordx4 v[116:119], v3, s[12:13] nt
    v_add_u32 v3, 5120, v3
    v_and_b32 v3, 0x1ffff, v3
    v_and_b32_dpp v12, v23, v4 row_newbcast:14 row_mask:0xf bank_mask:0xf
    v_and_b32_dpp v13, v23, v5 row_newbcast:14 row_mask:0xf bank_mask:0xf
    v_and_b32_dpp v14, v23, v6 row_newbcast:14 row_mask:0xf bank_mask:0xf
    v_and_b32_dpp v15, v23, v7 row_newbcast:14 row_mask:0xf bank_mask:0xf
    s_nop 1
    v_mfma_f32_16x16x32_bf16 v[28:31], v[12:15], v[136:139], v[28:31]
    s_waitcnt vmcnt(4)
    global_load_dwordx4 v[120:123], v3, s[12:13] nt
    v_add_u32 v3, 5120, v3
    v_and_b32 v3, 0x1ffff, v3
    v_and_b32_dpp v8, v23, v4 row_newbcast:15 row_mask:0xf bank_mask:0xf
    v_and_b32_dpp v9, v23, v5 row_newbcast:15 row_mask:0xf bank_mask:0xf
    v_and_b32_dpp v10, v23, v6 row_newbcast:15 row_mask:0xf bank_mask:0xf
    v_and_b32_dpp v11, v23, v7 row_newbcast:15 row_mask:0xf bank_mask:0xf
    s_nop 1
    v_mfma_f32_16x16x32_bf16 v[28:31], v[8:11], v[140:143], v[28:31]
    s_waitcnt vmcnt(4)
    global_load_dwordx4 v[124:127], v3, s[12:13] nt
    v_add_u32 v3, 5120, v3
    v_and_b32 v3, 0x1ffff, v3
    v_and_b32_dpp v12, v24, v4 row_newbcast:0 row_mask:0xf bank_mask:0xf
    v_and_b32_dpp v13, v24, v5 row_newbcast:0 row_mask:0xf bank_mask:0xf
    v_and_b32_dpp v14, v24, v6 row_newbcast:0 row_mask:0xf bank_mask:0xf
    v_and_b32_dpp v15, v24, v7 row_newbcast:0 row_mask:0xf bank_mask:0xf
    s_nop 1
    v_mfma_f32_16x16x32_bf16 v[28:31], v[12:15], v[144:147], v[28:31]
    s_waitcnt vmcnt(4)
    global_load_dwordx4 v[128:131], v3, s[12:13] nt
    v_add_u32 v3, 5120, v3
    v_and_b32 v3, 0x1ffff, v3
    v_and_b32_dpp v8, v24, v4 row_newbcast:1 row_mask:0xf bank_mask:0xf
    v_and_b32_dpp v9, v24, v5 row_newbcast:1 row_mask:0xf bank_mask:0xf
    v_and_b32_dpp v10, v24, v6 row_newbcast:1 row_mask:0xf bank_mask:0xf
    v_and_b32_dpp v11, v24, v7 row_newbcast:1 row_mask:0xf bank_mask:0xf
    s_nop 1
    v_mfma_f32_16x16x32_bf16 v[28:31], v[8:11], v[148:151], v[28:31]
    s_waitcnt vmcnt(4)
    global_load_dwordx4 v[132:135], v3, s[12:13] nt
    v_add_u32 v3, 5120, v3
    v_and_b32 v3, 0x1ffff, v3
    v_and_b32_dpp v12, v24, v4 row_newbcast:2 row_mask:0xf bank_mask:0xf
    v_and_b32_dpp v13, v24, v5 row_newbcast:2 row_mask:0xf bank_mask:0xf
    v_and_b32_dpp v14, v24, v6 row_newbcast:2 row_mask:0xf bank_mask:0xf
    v_and_b32_dpp v15, v24, v7 row_newbcast:2 row_mask:0xf bank_mask:0xf
    s_nop 1
    v_mfma_f32_16x16x32_bf16 v[28:31], v[12:15], v[152:155], v[28:31]
    s_waitcnt vmcnt(4)
    global_load_dwordx4 v[136:139], v3, s[12:13] nt
    v_add_u32 v3, 5120, v3
    v_and_b32 v3, 0x1ffff, v3
    v_and_b32_dpp v8, v24, v4 row_newbcast:3 row_mask:0xf bank_mask:0xf
    v_and_b32_dpp v9, v24, v5 row_newbcast:3 row_mask:0xf bank_mask:0xf
    v_and_b32_dpp v10, v24, v6 row_newbcast:3 row_mask:0xf bank_mask:0xf
    v_and_b32_dpp v11, v24, v7 row_newbcast:3 row_mask:0xf bank_mask:0xf
    s_nop 1
    v_mfma_f32_16x16x32_bf16 v[28:31], v[8:11], v[156:159], v[28:31]
    s_waitcnt vmcnt(4)
    global_load_dwordx4 v[140:143], v3, s[12:13] nt
    v_add_u32 v3, 5120, v3
    v_and_b32 v3, 0x1ffff, v3
    v_and_b32_dpp v12, v24, v4 row_newbcast:4 row_mask:0xf bank_mask:0xf
    v_and_b32_dpp v13, v24, v5 row_newbcast:4 row_mask:0xf bank_mask:0xf
    v_and_b32_dpp v14, v24, v6 row_newbcast:4 row_mask:0xf bank_mask:0xf
    v_and_b32_dpp v15, v24, v7 row_newbcast:4 row_mask:0xf bank_mask:0xf
    s_nop 1
    v_mfma_f32_16x16x32_bf16 v[28:31], v[12:15], v[160:163], v[28:31]
    s_waitcnt vmcnt(4)
    global_load_dwordx4 v[144:147], v3, s[12:13] nt
    v_add_u32 v3, 5120, v3
    v_and_b32 v3, 0x1ffff, v3
    v_and_b32_dpp v8, v24, v4 row_newbcast:5 row_mask:0xf bank_mask:0xf
    v_and_b32_dpp v9, v24, v5 row_newbcast:5 row_mask:0xf bank_mask:0xf
    v_and_b32_dpp v10, v24, v6 row_newbcast:5 row_mask:0xf bank_mask:0xf
    v_and_b32_dpp v11, v24, v7 row_newbcast:5 row_mask:0xf bank_mask:0xf
    s_nop 1
    v_mfma_f32_16x16x32_bf16 v[28:31], v[8:11], v[164:167], v[28:31]
    s_waitcnt vmcnt(4)
    global_load_dwordx4 v[148:151], v3, s[12:13] nt
    v_add_u32 v3, 5120, v3
    v_and_b32 v3, 0x1ffff, v3
    v_and_b32_dpp v12, v24, v4 row_newbcast:6 row_mask:0xf bank_mask:0xf
    v_and_b32_dpp v13, v24, v5 row_newbcast:6 row_mask:0xf bank_mask:0xf
    v_and_b32_dpp v14, v24, v6 row_newbcast:6 row_mask:0xf bank_mask:0xf
    v_and_b32_dpp v15, v24, v7 row_newbcast:6 row_mask:0xf bank_mask:0xf
    s_nop 1
    v_mfma_f32_16x16x32_bf16 v[28:31], v[12:15], v[168:171], v[28:31]
    s_waitcnt vmcnt(4)
    global_load_dwordx4 v[152:155], v3, s[12:13] nt
    v_add_u32 v3, 5120, v3
    v_and_b32 v3, 0x1ffff, v3
    v_and_b32_dpp v8, v24, v4 row_newbcast:7 row_mask:0xf bank_mask:0xf
    v_and_b32_dpp v9, v24, v5 row_newbcast:7 row_mask:0xf bank_mask:0xf
    v_and_b32_dpp v10, v24, v6 row_newbcast:7 row_mask:0xf bank_mask:0xf
    v_and_b32_dpp v11, v24, v7 row_newbcast:7 row_mask:0xf bank_mask:0xf
    s_nop 1
    v_mfma_f32_16x16x32_bf16 v[28:31], v[8:11], v[172:175], v[28:31]
    s_waitcnt vmcnt(4)
    global_load_dwordx4 v[156:159], v3, s[12:13] nt
    v_add_u32 v3, 5120, v3
    v_and_b32 v3, 0x1ffff, v3
    v_and_b32_dpp v12, v24, v4 row_newbcast:8 row_mask:0xf bank_mask:0xf
    v_and_b32_dpp v13, v24, v5 row_newbcast:8 row_mask:0xf bank_mask:0xf
    v_and_b32_dpp v14, v24, v6 row_newbcast:8 row_mask:0xf bank_mask:0xf
    v_and_b32_dpp v15, v24, v7 row_newbcast:8 row_mask:0xf bank_mask:0xf
    s_nop 1
    v_mfma_f32_16x16x32_bf16 v[28:31], v[12:15], v[96:99], v[28:31]
    s_waitcnt vmcnt(4)
    global_load_dwordx4 v[160:163], v3, s[12:13] nt
    v_add_u32 v3, 5120, v3
    v_and_b32 v3, 0x1ffff, v3
    s_cmp_eq_u32 s39, 0
    s_cbranch_scc1 Lts8
    s_mov_b32 s3, 0x40000
Lr9:
    v_xor_b32 v40, s38, v177
    v_xor_b32 v41, s38, v179
    v_or_b32 v40, v40, v41
    v_xor_b32 v41, s38, v181
    v_or_b32 v40, v40, v41
    v_xor_b32 v41, s38, v183
    v_or_b32 v40, v40, v41
    v_xor_b32 v41, s38, v185
    v_or_b32 v40, v40, v41
    v_xor_b32 v41, s38, v187
    v_or_b32 v40, v40, v41
    v_xor_b32 v41, s38, v189
    v_or_b32 v40, v40, v41
    v_xor_b32 v41, s38, v191
    v_or_b32 v40, v40, v41
    v_xor_b32 v41, s38, v193
    v_or_b32 v40, v40, v41
    v_xor_b32 v41, s38, v195
    v_or_b32 v40, v40, v41
    v_xor_b32 v41, s38, v197
    v_or_b32 v40, v40, v41
    v_xor_b32 v41, s38, v199
    v_or_b32 v40, v40, v41
    v_xor_b32 v41, s38, v201
    v_or_b32 v40, v40, v41
    v_xor_b32 v41, s38, v203
    v_or_b32 v40, v40, v41
    v_xor_b32 v41, s38, v205
    v_or_b32 v40, v40, v41
    v_xor_b32 v41, s38, v207
    v_or_b32 v40, v40, v41
    v_cmp_ne_u32 vcc, 0, v40
    s_cbranch_vccz Lo10
    s_sub_u32 s3, s3, 1
    s_cbranch_scc1 Lo10
    s_sleep 2
    s_movk_i32 s55, 0
    buffer_load_dwordx4 v[176:179], v68, s[48:51], s55 offen sc1
    s_movk_i32 s55, 4096
    buffer_load_dwordx4 v[180:183], v68, s[48:51], s55 offen sc1
    s_movk_i32 s55, 8192
    buffer_load_dwordx4 v[184:187], v68, s[48:51], s55 offen sc1
    s_movk_i32 s55, 12288
    buffer_load_dwordx4 v[188:191], v68, s[48:51], s55 offen sc1
    s_movk_i32 s55, 16384
    buffer_load_dwordx4 v[192:195], v68, s[48:51], s55 offen sc1
    s_movk_i32 s55, 20480
    buffer_load_dwordx4 v[196:199], v68, s[48:51], s55 offen sc1
    s_movk_i32 s55, 24576
    buffer_load_dwordx4 v[200:203], v68, s[48:51], s55 offen sc1
    s_movk_i32 s55, 28672
    buffer_load_dwordx4 v[204:207], v68, s[48:51], s55 offen sc1
    s_waitcnt vmcnt(0)
    s_branch Lr9
Lo10:
    v_lshlrev_b32 v40, 3, v0
    v_mov_b32 v177, v178
    ds_write_b64 v40, v[176:177] offset:36864
    v_mov_b32 v181, v182
    ds_write_b64 v40, v[180:181] offset:38912
    v_mov_b32 v185, v186
    ds_write_b64 v40, v[184:185] offset:40960
    v_mov_b32 v189, v190
    ds_write_b64 v40, v[188:189] offset:43008
    v_mov_b32 v193, v194
    ds_write_b64 v40, v[192:193] offset:45056
    v_mov_b32 v197, v198
    ds_write_b64 v40, v[196:197] offset:47104
    v_mov_b32 v201, v202
    ds_write_b64 v40, v[200:201] offset:49152
    v_mov_b32 v205, v206
    ds_write_b64 v40, v[204:205] offset:51200
    v_lshlrev_b32 v88, 16, v88
    v_lshlrev_b32 v89, 16, v89
    v_lshlrev_b32 v90, 16, v90
    v_lshlrev_b32 v91, 16, v91
Lts8:
    v_and_b32_dpp v8, v24, v4 row_newbcast:9 row_mask:0xf bank_mask:0xf
    v_and_b32_dpp v9, v24, v5 row_newbcast:9 row_mask:0xf bank_mask:0xf
    v_and_b32_dpp v10, v24, v6 row_newbcast:9 row_mask:0xf bank_mask:0xf
    v_and_b32_dpp v11, v24, v7 row_newbcast:9 row_mask:0xf bank_mask:0xf
    s_nop 1
    v_mfma_f32_16x16x32_bf16 v[28:31], v[8:11], v[100:103], v[28:31]
    s_waitcnt vmcnt(4)
    global_load_dwordx4 v[164:167], v3, s[12:13] nt
    v_add_u32 v3, 5120, v3
    v_and_b32 v3, 0x1ffff, v3
    v_and_b32_dpp v12, v24, v4 row_newbcast:10 row_mask:0xf bank_mask:0xf
    v_and_b32_dpp v13, v24, v5 row_newbcast:10 row_mask:0xf bank_mask:0xf
    v_and_b32_dpp v14, v24, v6 row_newbcast:10 row_mask:0xf bank_mask:0xf
    v_and_b32_dpp v15, v24, v7 row_newbcast:10 row_mask:0xf bank_mask:0xf
    s_nop 1
    v_mfma_f32_16x16x32_bf16 v[28:31], v[12:15], v[104:107], v[28:31]
    s_waitcnt vmcnt(4)
    global_load_dwordx4 v[168:171], v3, s[12:13] nt
    v_add_u32 v3, 5120, v3
    v_and_b32 v3, 0x1ffff, v3
    v_and_b32_dpp v8, v24, v4 row_newbcast:11 row_mask:0xf bank_mask:0xf
    v_and_b32_dpp v9, v24, v5 row_newbcast:11 row_mask:0xf bank_mask:0xf
    v_and_b32_dpp v10, v24, v6 row_newbcast:11 row_mask:0xf bank_mask:0xf
    v_and_b32_dpp v11, v24, v7 row_newbcast:11 row_mask:0xf bank_mask:0xf
    s_nop 1
    v_mfma_f32_16x16x32_bf16 v[28:31], v[8:11], v[108:111], v[28:31]
    s_waitcnt vmcnt(4)
    global_load_dwordx4 v[172:175], v3, s[12:13] nt
    v_add_u32 v3, 5120, v3
    v_and_b32 v3, 0x1ffff, v3
    v_and_b32_dpp v12, v24, v4 row_newbcast:12 row_mask:0xf bank_mask:0xf
    v_and_b32_dpp v13, v24, v5 row_newbcast:12 row_mask:0xf bank_mask:0xf
    v_and_b32_dpp v14, v24, v6 row_newbcast:12 row_mask:0xf bank_mask:0xf
    v_and_b32_dpp v15, v24, v7 row_newbcast:12 row_mask:0xf bank_mask:0xf
    s_nop 1
    v_mfma_f32_16x16x32_bf16 v[28:31], v[12:15], v[112:115], v[28:31]
    s_waitcnt vmcnt(4)
    global_load_dwordx4 v[96:99], v3, s[12:13] nt
    v_add_u32 v3, 5120, v3
    v_and_b32 v3, 0x1ffff, v3
    v_and_b32_dpp v8, v24, v4 row_newbcast:13 row_mask:0xf bank_mask:0xf
    v_and_b32_dpp v9, v24, v5 row_newbcast:13 row_mask:0xf bank_mask:0xf
    v_and_b32_dpp v10, v24, v6 row_newbcast:13 row_mask:0xf bank_mask:0xf
    v_and_b32_dpp v11, v24, v7 row_newbcast:13 row_mask:0xf bank_mask:0xf
    s_nop 1
    v_mfma_f32_16x16x32_bf16 v[28:31], v[8:11], v[116:119], v[28:31]
    s_waitcnt vmcnt(4)
    global_load_dwordx4 v[100:103], v3, s[12:13] nt
    v_add_u32 v3, 5120, v3
    v_and_b32 v3, 0x1ffff, v3
    v_and_b32_dpp v12, v24, v4 row_newbcast:14 row_mask:0xf bank_mask:0xf
    v_and_b32_dpp v13, v24, v5 row_newbcast:14 row_mask:0xf bank_mask:0xf
    v_and_b32_dpp v14, v24, v6 row_newbcast:14 row_mask:0xf bank_mask:0xf
    v_and_b32_dpp v15, v24, v7 row_newbcast:14 row_mask:0xf bank_mask:0xf
    s_nop 1
    v_mfma_f32_16x16x32_bf16 v[28:31], v[12:15], v[120:123], v[28:31]
    s_waitcnt vmcnt(4)
    global_load_dwordx4 v[104:107], v3, s[12:13] nt
    v_add_u32 v3, 5120, v3
    v_and_b32 v3, 0x1ffff, v3
    v_and_b32_dpp v8, v24, v4 row_newbcast:15 row_mask:0xf bank_mask:0xf
    v_and_b32_dpp v9, v24, v5 row_newbcast:15 row_mask:0xf bank_mask:0xf
    v_and_b32_dpp v10, v24, v6 row_newbcast:15 row_mask:0xf bank_mask:0xf
    v_and_b32_dpp v11, v24, v7 row_newbcast:15 row_mask:0xf bank_mask:0xf
    s_nop 1
    v_mfma_f32_16x16x32_bf16 v[28:31], v[8:11], v[124:127], v[28:31]
    s_waitcnt vmcnt(4)
    global_load_dwordx4 v[108:111], v3, s[12:13] nt
    v_add_u32 v3, 5120, v3
    v_and_b32 v3, 0x1ffff, v3
    v_and_b32_dpp v12, v25, v4 row_newbcast:0 row_mask:0xf bank_mask:0xf
    v_and_b32_dpp v13, v25, v5 row_newbcast:0 row_mask:0xf bank_mask:0xf
    v_and_b32_dpp v14, v25, v6 row_newbcast:0 row_mask:0xf bank_mask:0xf
    v_and_b32_dpp v15, v25, v7 row_newbcast:0 row_mask:0xf bank_mask:0xf
    s_nop 1
    v_mfma_f32_16x16x32_bf16 v[28:31], v[12:15], v[128:131], v[28:31]
    s_waitcnt vmcnt(4)
    global_load_dwordx4 v[112:115], v3, s[12:13] nt
    v_add_u32 v3, 5120, v3
    v_and_b32 v3, 0x1ffff, v3
    s_cmp_lg_u32 s34, 0
    s_cbranch_scc1 Lw011
    global_load_dwordx4 v[56:59], v67, s[32:33] sc1
Lw011:
    v_and_b32_dpp v8, v25, v4 row_newbcast:1 row_mask:0xf bank_mask:0xf
    v_and_b32_dpp v9, v25, v5 row_newbcast:1 row_mask:0xf bank_mask:0xf
    v_and_b32_dpp v10, v25, v6 row_newbcast:1 row_mask:0xf bank_mask:0xf
    v_and_b32_dpp v11, v25, v7 row_newbcast:1 row_mask:0xf bank_mask:0xf
    s_nop 1
    v_mfma_f32_16x16x32_bf16 v[28:31], v[8:11], v[132:135], v[28:31]
    s_waitcnt vmcnt(4)
    global_load_dwordx4 v[116:119], v3, s[12:13] nt
    v_add_u32 v3, 5120, v3
    v_and_b32 v3, 0x1ffff, v3
    v_and_b32_dpp v12, v25, v4 row_newbcast:2 row_mask:0xf bank_mask:0xf
    v_and_b32_dpp v13, v25, v5 row_newbcast:2 row_mask:0xf bank_mask:0xf
    v_and_b32_dpp v14, v25, v6 row_newbcast:2 row_mask:0xf bank_mask:0xf
    v_and_b32_dpp v15, v25, v7 row_newbcast:2 row_mask:0xf bank_mask:0xf
    s_nop 1
    v_mfma_f32_16x16x32_bf16 v[28:31], v[12:15], v[136:139], v[28:31]
    s_waitcnt vmcnt(4)
    global_load_dwordx4 v[120:123], v3, s[12:13] nt
    v_add_u32 v3, 5120, v3
    v_and_b32 v3, 0x1ffff, v3
    v_and_b32_dpp v8, v25, v4 row_newbcast:3 row_mask:0xf bank_mask:0xf
    v_and_b32_dpp v9, v25, v5 row_newbcast:3 row_mask:0xf bank_mask:0xf
    v_and_b32_dpp v10, v25, v6 row_newbcast:3 row_mask:0xf bank_mask:0xf
    v_and_b32_dpp v11, v25, v7 row_newbcast:3 row_mask:0xf bank_mask:0xf
    s_nop 1
    v_mfma_f32_16x16x32_bf16 v[28:31], v[8:11], v[140:143], v[28:31]
    s_waitcnt vmcnt(4)
    global_load_dwordx4 v[124:127], v3, s[12:13] nt
    v_add_u32 v3, 5120, v3
    v_and_b32 v3, 0x1ffff, v3
    v_and_b32_dpp v12, v25, v4 row_newbcast:4 row_mask:0xf bank_mask:0xf
    v_and_b32_dpp v13, v25, v5 row_newbcast:4 row_mask:0xf bank_mask:0xf
    v_and_b32_dpp v14, v25, v6 row_newbcast:4 row_mask:0xf bank_mask:0xf
    v_and_b32_dpp v15, v25, v7 row_newbcast:4 row_mask:0xf bank_mask:0xf
    s_nop 1
    v_mfma_f32_16x16x32_bf16 v[28:31], v[12:15], v[144:147], v[28:31]
    s_waitcnt vmcnt(4)
    global_load_dwordx4 v[128:131], v3, s[12:13] nt
    v_add_u32 v3, 5120, v3
    v_and_b32 v3, 0x1ffff, v3
    v_and_b32_dpp v8, v25, v4 row_newbcast:5 row_mask:0xf bank_mask:0xf
    v_and_b32_dpp v9, v25, v5 row_newbcast:5 row_mask:0xf bank_mask:0xf
    v_and_b32_dpp v10, v25, v6 row_newbcast:5 row_mask:0xf bank_mask:0xf
    v_and_b32_dpp v11, v25, v7 row_newbcast:5 row_mask:0xf bank_mask:0xf
    s_nop 1
    v_mfma_f32_16x16x32_bf16 v[28:31], v[8:11], v[148:151], v[28:31]
    s_waitcnt vmcnt(4)
    global_load_dwordx4 v[132:135], v3, s[12:13] nt
    v_add_u32 v3, 5120, v3
    v_and_b32 v3, 0x1ffff, v3
    v_and_b32_dpp v12, v25, v4 row_newbcast:6 row_mask:0xf bank_mask:0xf
    v_and_b32_dpp v13, v25, v5 row_newbcast:6 row_mask:0xf bank_mask:0xf
    v_and_b32_dpp v14, v25, v6 row_newbcast:6 row_mask:0xf bank_mask:0xf
    v_and_b32_dpp v15, v25, v7 row_newbcast:6 row_mask:0xf bank_mask:0xf
    s_nop 1
    v_mfma_f32_16x16x32_bf16 v[28:31], v[12:15], v[152:155], v[28:31]
    s_waitcnt vmcnt(4)
    global_load_dwordx4 v[136:139], v3, s[12:13] nt
    v_add_u32 v3, 5120, v3
    v_and_b32 v3, 0x1ffff, v3
    v_and_b32_dpp v8, v25, v4 row_newbcast:7 row_mask:0xf bank_mask:0xf
    v_and_b32_dpp v9, v25, v5 row_newbcast:7 row_mask:0xf bank_mask:0xf
    v_and_b32_dpp v10, v25, v6 row_newbcast:7 row_mask:0xf bank_mask:0xf
    v_and_b32_dpp v11, v25, v7 row_newbcast:7 row_mask:0xf bank_mask:0xf
    s_nop 1
    v_mfma_f32_16x16x32_bf16 v[28:31], v[8:11], v[156:159], v[28:31]
    s_waitcnt vmcnt(4)
    global_load_dwordx4 v[140:143], v3, s[12:13] nt
    v_add_u32 v3, 5120, v3
    v_and_b32 v3, 0x1ffff, v3
    v_and_b32_dpp v12, v25, v4 row_newbcast:8 row_mask:0xf bank_mask:0xf
    v_and_b32_dpp v13, v25, v5 row_newbcast:8 row_mask:0xf bank_mask:0xf
    v_and_b32_dpp v14, v25, v6 row_newbcast:8 row_mask:0xf bank_mask:0xf
    v_and_b32_dpp v15, v25, v7 row_newbcast:8 row_mask:0xf bank_mask:0xf
    s_nop 1
    v_mfma_f32_16x16x32_bf16 v[28:31], v[12:15], v[160:163], v[28:31]
    s_waitcnt vmcnt(4)
    global_load_dwordx4 v[144:147], v3, s[12:13] nt
    v_add_u32 v3, 5120, v3
    v_and_b32 v3, 0x1ffff, v3
    v_and_b32_dpp v8, v25, v4 row_newbcast:9 row_mask:0xf bank_mask:0xf
    v_and_b32_dpp v9, v25, v5 row_newbcast:9 row_mask:0xf bank_mask:0xf
    v_and_b32_dpp v10, v25, v6 row_newbcast:9 row_mask:0xf bank_mask:0xf
    v_and_b32_dpp v11, v25, v7 row_newbcast:9 row_mask:0xf bank_mask:0xf
    s_nop 1
    v_mfma_f32_16x16x32_bf16 v[28:31], v[8:11], v[164:167], v[28:31]
    s_waitcnt vmcnt(4)
    global_load_dwordx4 v[148:151], v3, s[12:13] nt
    v_add_u32 v3, 5120, v3
    v_and_b32 v3, 0x1ffff, v3
    v_and_b32_dpp v12, v25, v4 row_newbcast:10 row_mask:0xf bank_mask:0xf
    v_and_b32_dpp v13, v25, v5 row_newbcast:10 row_mask:0xf bank_mask:0xf
    v_and_b32_dpp v14, v25, v6 row_newbcast:10 row_mask:0xf bank_mask:0xf
    v_and_b32_dpp v15, v25, v7 row_newbcast:10 row_mask:0xf bank_mask:0xf
    s_nop 1
    v_mfma_f32_16x16x32_bf16 v[28:31], v[12:15], v[168:171], v[28:31]
    s_waitcnt vmcnt(4)
    global_load_dwordx4 v[152:155], v3, s[12:13] nt
    v_add_u32 v3, 5120, v3
    v_and_b32 v3, 0x1ffff, v3
    v_and_b32_dpp v8, v25, v4 row_newbcast:11 row_mask:0xf bank_mask:0xf
    v_and_b32_dpp v9, v25, v5 row_newbcast:11 row_mask:0xf bank_mask:0xf
    v_and_b32_dpp v10, v25, v6 row_newbcast:11 row_mask:0xf bank_mask:0xf
    v_and_b32_dpp v11, v25, v7 row_newbcast:11 row_mask:0xf bank_mask:0xf
    s_nop 1
    v_mfma_f32_16x16x32_bf16 v[28:31], v[8:11], v[172:175], v[28:31]
    s_waitcnt vmcnt(4)
    global_load_dwordx4 v[156:159], v3, s[12:13] nt
    v_add_u32 v3, 5120, v3
    v_and_b32 v3, 0x1ffff, v3
    v_and_b32_dpp v12, v25, v4 row_newbcast:12 row_mask:0xf bank_mask:0xf
    v_and_b32_dpp v13, v25, v5 row_newbcast:12 row_mask:0xf bank_mask:0xf
    v_and_b32_dpp v14, v25, v6 row_newbcast:12 row_mask:0xf bank_mask:0xf
    v_and_b32_dpp v15, v25, v7 row_newbcast:12 row_mask:0xf bank_mask:0xf
    s_nop 1
    v_mfma_f32_16x16x32_bf16 v[28:31], v[12:15], v[96:99], v[28:31]
    s_waitcnt vmcnt(4)
    global_load_dwordx4 v[160:163], v3, s[12:13] nt
    v_add_u32 v3, 5120, v3
    v_and_b32 v3, 0x1ffff, v3
    v_and_b32_dpp v8, v25, v4 row_newbcast:13 row_mask:0xf bank_mask:0xf
    v_and_b32_dpp v9, v25, v5 row_newbcast:13 row_mask:0xf bank_mask:0xf
    v_and_b32_dpp v10, v25, v6 row_newbcast:13 row_mask:0xf bank_mask:0xf
    v_and_b32_dpp v11, v25, v7 row_newbcast:13 row_mask:0xf bank_mask:0xf
    s_nop 1
    v_mfma_f32_16x16x32_bf16 v[28:31], v[8:11], v[100:103], v[28:31]
    s_waitcnt vmcnt(4)
    global_load_dwordx4 v[164:167], v3, s[12:13] nt
    v_add_u32 v3, 5120, v3
    v_and_b32 v3, 0x1ffff, v3
    v_and_b32_dpp v12, v25, v4 row_newbcast:14 row_mask:0xf bank_mask:0xf
    v_and_b32_dpp v13, v25, v5 row_newbcast:14 row_mask:0xf bank_mask:0xf
    v_and_b32_dpp v14, v25, v6 row_newbcast:14 row_mask:0xf bank_mask:0xf
    v_and_b32_dpp v15, v25, v7 row_newbcast:14 row_mask:0xf bank_mask:0xf
    s_nop 1
    v_mfma_f32_16x16x32_bf16 v[28:31], v[12:15], v[104:107], v[28:31]
    s_waitcnt vmcnt(4)
    global_load_dwordx4 v[168:171], v3, s[12:13] nt
    v_add_u32 v3, 5120, v3
    v_and_b32 v3, 0x1ffff, v3
    v_and_b32_dpp v8, v25, v4 row_newbcast:15 row_mask:0xf bank_mask:0xf
    v_and_b32_dpp v9, v25, v5 row_newbcast:15 row_mask:0xf bank_mask:0xf
    v_and_b32_dpp v10, v25, v6 row_newbcast:15 row_mask:0xf bank_mask:0xf
    v_and_b32_dpp v11, v25, v7 row_newbcast:15 row_mask:0xf bank_mask:0xf
    s_nop 1
    v_mfma_f32_16x16x32_bf16 v[28:31], v[8:11], v[108:111], v[28:31]
    s_waitcnt vmcnt(4)
    global_load_dwordx4 v[172:175], v3, s[12:13] nt
    v_add_u32 v3, 5120, v3
    v_and_b32 v3, 0x1ffff, v3
    v_and_b32_dpp v12, v26, v4 row_newbcast:0 row_mask:0xf bank_mask:0xf
    v_and_b32_dpp v13, v26, v5 row_newbcast:0 row_mask:0xf bank_mask:0xf
    v_and_b32_dpp v14, v26, v6 row_newbcast:0 row_mask:0xf bank_mask:0xf
    v_and_b32_dpp v15, v26, v7 row_newbcast:0 row_mask:0xf bank_mask:0xf
    s_nop 1
    v_mfma_f32_16x16x32_bf16 v[28:31], v[12:15], v[112:115], v[28:31]
    s_waitcnt vmcnt(4)
    global_load_dwordx4 v[96:99], v3, s[12:13] nt
    v_add_u32 v3, 5120, v3
    v_and_b32 v3, 0x1ffff, v3
    v_and_b32_dpp v8, v26, v4 row_newbcast:1 row_mask:0xf bank_mask:0xf
    v_and_b32_dpp v9, v26, v5 row_newbcast:1 row_mask:0xf bank_mask:0xf
    v_and_b32_dpp v10, v26, v6 row_newbcast:1 row_mask:0xf bank_mask:0xf
    v_and_b32_dpp v11, v26, v7 row_newbcast:1 row_mask:0xf bank_mask:0xf
    s_nop 1
    v_mfma_f32_16x16x32_bf16 v[28:31], v[8:11], v[116:119], v[28:31]
    s_waitcnt vmcnt(4)
    global_load_dwordx4 v[100:103], v3, s[12:13] nt
    v_add_u32 v3, 5120, v3
    v_and_b32 v3, 0x1ffff, v3
    v_and_b32_dpp v12, v26, v4 row_newbcast:2 row_mask:0xf bank_mask:0xf
    v_and_b32_dpp v13, v26, v5 row_newbcast:2 row_mask:0xf bank_mask:0xf
    v_and_b32_dpp v14, v26, v6 row_newbcast:2 row_mask:0xf bank_mask:0xf
    v_and_b32_dpp v15, v26, v7 row_newbcast:2 row_mask:0xf bank_mask:0xf
    s_nop 1
    v_mfma_f32_16x16x32_bf16 v[28:31], v[12:15], v[120:123], v[28:31]
    s_waitcnt vmcnt(4)
    global_load_dwordx4 v[104:107], v3, s[12:13] nt
    v_add_u32 v3, 5120, v3
    v_and_b32 v3, 0x1ffff, v3
    v_and_b32_dpp v8, v26, v4 row_newbcast:3 row_mask:0xf bank_mask:0xf
    v_and_b32_dpp v9, v26, v5 row_newbcast:3 row_mask:0xf bank_mask:0xf
    v_and_b32_dpp v10, v26, v6 row_newbcast:3 row_mask:0xf bank_mask:0xf
    v_and_b32_dpp v11, v26, v7 row_newbcast:3 row_mask:0xf bank_mask:0xf
    s_nop 1
    v_mfma_f32_16x16x32_bf16 v[28:31], v[8:11], v[124:127], v[28:31]
    s_waitcnt vmcnt(4)
    global_load_dwordx4 v[108:111], v3, s[12:13] nt
    v_add_u32 v3, 5120, v3
    v_and_b32 v3, 0x1ffff, v3
    v_and_b32_dpp v12, v26, v4 row_newbcast:4 row_mask:0xf bank_mask:0xf
    v_and_b32_dpp v13, v26, v5 row_newbcast:4 row_mask:0xf bank_mask:0xf
    v_and_b32_dpp v14, v26, v6 row_newbcast:4 row_mask:0xf bank_mask:0xf
    v_and_b32_dpp v15, v26, v7 row_newbcast:4 row_mask:0xf bank_mask:0xf
    s_nop 1
    v_mfma_f32_16x16x32_bf16 v[28:31], v[12:15], v[128:131], v[28:31]
    s_waitcnt vmcnt(4)
    global_load_dwordx4 v[112:115], v3, s[12:13] nt
    v_add_u32 v3, 5120, v3
    v_and_b32 v3, 0x1ffff, v3
    v_and_b32_dpp v8, v26, v4 row_newbcast:5 row_mask:0xf bank_mask:0xf
    v_and_b32_dpp v9, v26, v5 row_newbcast:5 row_mask:0xf bank_mask:0xf
    v_and_b32_dpp v10, v26, v6 row_newbcast:5 row_mask:0xf bank_mask:0xf
    v_and_b32_dpp v11, v26, v7 row_newbcast:5 row_mask:0xf bank_mask:0xf
    s_nop 1
    v_mfma_f32_16x16x32_bf16 v[28:31], v[8:11], v[132:135], v[28:31]
    s_waitcnt vmcnt(4)
    global_load_dwordx4 v[116:119], v3, s[12:13] nt
    v_add_u32 v3, 5120, v3
    v_and_b32 v3, 0x1ffff, v3
    v_and_b32_dpp v12, v26, v4 row_newbcast:6 row_mask:0xf bank_mask:0xf
    v_and_b32_dpp v13, v26, v5 row_newbcast:6 row_mask:0xf bank_mask:0xf
    v_and_b32_dpp v14, v26, v6 row_newbcast:6 row_mask:0xf bank_mask:0xf
    v_and_b32_dpp v15, v26, v7 row_newbcast:6 row_mask:0xf bank_mask:0xf
    s_nop 1
    v_mfma_f32_16x16x32_bf16 v[28:31], v[12:15], v[136:139], v[28:31]
    s_waitcnt vmcnt(4)
    global_load_dwordx4 v[120:123], v3, s[12:13] nt
    v_add_u32 v3, 5120, v3
    v_and_b32 v3, 0x1ffff, v3
    v_and_b32_dpp v8, v26, v4 row_newbcast:7 row_mask:0xf bank_mask:0xf
    v_and_b32_dpp v9, v26, v5 row_newbcast:7 row_mask:0xf bank_mask:0xf
    v_and_b32_dpp v10, v26, v6 row_newbcast:7 row_mask:0xf bank_mask:0xf
    v_and_b32_dpp v11, v26, v7 row_newbcast:7 row_mask:0xf bank_mask:0xf
    s_nop 1
    v_mfma_f32_16x16x32_bf16 v[28:31], v[8:11], v[140:143], v[28:31]
    s_waitcnt vmcnt(4)
    global_load_dwordx4 v[124:127], v3, s[12:13] nt
    v_add_u32 v3, 5120, v3
    v_and_b32 v3, 0x1ffff, v3
    v_and_b32_dpp v12, v26, v4 row_newbcast:8 row_mask:0xf bank_mask:0xf
    v_and_b32_dpp v13, v26, v5 row_newbcast:8 row_mask:0xf bank_mask:0xf
    v_and_b32_dpp v14, v26, v6 row_newbcast:8 row_mask:0xf bank_mask:0xf
    v_and_b32_dpp v15, v26, v7 row_newbcast:8 row_mask:0xf bank_mask:0xf
    s_nop 1
    v_mfma_f32_16x16x32_bf16 v[28:31], v[12:15], v[144:147], v[28:31]
    s_waitcnt vmcnt(4)
    global_load_dwordx4 v[128:131], v3, s[12:13] nt
    v_add_u32 v3, 5120, v3
    v_and_b32 v3, 0x1ffff, v3
    global_load_dwordx4 v[132:135], v3, s[12:13] nt
    v_add_u32 v3, 5120, v3
    v_and_b32 v3, 0x1ffff, v3
    global_load_dwordx4 v[136:139], v3, s[12:13] nt
    v_add_u32 v3, 5120, v3
    v_and_b32 v3, 0x1ffff, v3
    global_load_dwordx4 v[140:143], v3, s[12:13] nt
    v_add_u32 v3, 5120, v3
    v_and_b32 v3, 0x1ffff, v3
    global_load_dwordx4 v[144:147], v3, s[12:13] nt
    v_add_u32 v3, 5120, v3
    v_and_b32 v3, 0x1ffff, v3
    s_cmp_lg_u32 s34, 0
    s_cbranch_scc1 Lw012
    s_mov_b32 s3, 0x40000
Lr13:
    v_xor_b32 v40, s38, v57
    v_xor_b32 v41, s38, v59
    v_or_b32 v40, v40, v41
    v_cmp_ne_u32 vcc, 0, v40
    s_cbranch_vccz Lo14
    s_sub_u32 s3, s3, 1
    s_cbranch_scc1 Lo14
    s_sleep 2
    global_load_dwordx4 v[56:59], v67, s[32:33] sc1
    s_waitcnt vmcnt(0)
    s_branch Lr13
Lo14:
    s_mov_b32 exec_lo, 0xffff0000
    v_mov_b32 v56, s52
    v_mov_b32 v58, 0
    s_mov_b32 exec_lo, -1
    v_mov_b32 v40, v56
    s_nop 1
    v_max_f32_dpp v40, v40, v40 row_ror:8 row_mask:0xf bank_mask:0xf
    s_nop 1
    v_max_f32_dpp v40, v40, v40 row_ror:4 row_mask:0xf bank_mask:0xf
    s_nop 1
    v_max_f32_dpp v40, v40, v40 row_ror:2 row_mask:0xf bank_mask:0xf
    s_nop 1
    v_max_f32_dpp v40, v40, v40 row_ror:1 row_mask:0xf bank_mask:0xf
    s_nop 1
    v_max_f32_dpp v40, v40, v40 row_bcast:15 row_mask:0xa bank_mask:0xf
    s_nop 1
    v_max_f32_dpp v40, v40, v40 row_bcast:31 row_mask:0xc bank_mask:0xf
    s_nop 1
    v_readlane_b32 s53, v40, 63
    s_nop 1
    v_subrev_f32 v56, s53, v56
    v_mul_f32 v56, 0x3fb8aa3b, v56
    v_exp_f32 v56, v56
    s_nop 0
    v_mul_f32 v40, v56, v58
    s_nop 1
    v_add_f32_dpp v40, v40, v40 row_ror:8 row_mask:0xf bank_mask:0xf
    s_nop 1
    v_add_f32_dpp v40, v40, v40 row_ror:4 row_mask:0xf bank_mask:0xf
    s_nop 1
    v_add_f32_dpp v40, v40, v40 row_ror:2 row_mask:0xf bank_mask:0xf
    s_nop 1
    v_add_f32_dpp v40, v40, v40 row_ror:1 row_mask:0xf bank_mask:0xf
    s_nop 1
    v_add_f32_dpp v40, v40, v40 row_bcast:15 row_mask:0xa bank_mask:0xf
    s_nop 1
    v_add_f32_dpp v40, v40, v40 row_bcast:31 row_mask:0xc bank_mask:0xf
    s_nop 1
    v_readlane_b32 s53, v40, 63
    s_nop 1
    v_rcp_f32 v40, s53
    s_lshl_b32 s55, s37, 2
    v_mul_f32 v56, v56, v40
    v_subrev_u32 v40, s55, v1
    v_lshlrev_b32 v40, 2, v40
    s_lshl_b64 exec, 15, s55
    ds_write_b32 v40, v56 offset:53376
    s_mov_b64 exec, -1
Lw012:
    v_lshrrev_b32 v60, 3, v65
    v_lshlrev_b32 v41, 10, v60
    v_lshlrev_b32 v60, 3, v60
    s_lshl_b32 s55, s34, 9
    v_add_u32 v61, s55, v2
    v_and_b32 v40, 1, v65
    v_lshl_add_u32 v41, v40, 8, v41
    v_bfe_u32 v42, v65, 1, 2
    v_lshl_add_u32 v41, v42, 4, v41
    v_lshl_add_u32 v41, v64, 2, v41
    s_lshl_b32 s55, s34, 6
    v_add_u32 v62, s55, v41
    s_mul_i32 s55, s34, 2560
    v_lshlrev_b32 v40, 5, v65
    v_lshl_add_u32 v40, v64, 4, v40
    v_add_u32 v63, s55, v40
    v_add_u32 v40, 0, v0
    v_lshlrev_b32 v76, 2, v40
    v_lshrrev_b32 v41, 2, v40
    v_and_b32 v40, 3, v40
    v_mad_u32_u24 v41, v41, 3, v40
    v_min_u32 v72, 639, v41
    v_lshlrev_b32 v72, 2, v72
    v_add_u32 v40, 256, v0
    v_lshlrev_b32 v77, 2, v40
    v_lshrrev_b32 v41, 2, v40
    v_and_b32 v40, 3, v40
    v_mad_u32_u24 v41, v41, 3, v40
    v_min_u32 v73, 639, v41
    v_lshlrev_b32 v73, 2, v73
    v_add_u32 v40, 512, v0
    v_lshlrev_b32 v78, 2, v40
    v_lshrrev_b32 v41, 2, v40
    v_and_b32 v40, 3, v40
    v_mad_u32_u24 v41, v41, 3, v40
    v_min_u32 v74, 639, v41
    v_lshlrev_b32 v74, 2, v74
    v_add_u32 v40, 768, v0
    v_lshlrev_b32 v79, 2, v40
    v_lshrrev_b32 v41, 2, v40
    v_and_b32 v40, 3, v40
    v_mad_u32_u24 v41, v41, 3, v40
    v_min_u32 v75, 639, v41
    v_lshlrev_b32 v75, 2, v75
    s_movk_i32 s55, 639
    v_cmp_lt_u32 s[6:7], s55, v41
    s_mov_b32 s4, 0x88888888
    s_mov_b32 s5, 0x88888888
    v_min_u32 v66, 213, v0
    v_lshlrev_b32 v66, 4, v66
    v_mul_u32_u24 v40, 3, v0
    s_movk_i32 s55, 640
    v_cmp_gt_u32 s[56:57], s55, v40
    s_movk_i32 s55, 639
    v_cmp_gt_u32 s[58:59], s55, v40
    s_mul_i32 s55, s36, 1280
    v_lshl_add_u32 v40, v40, 1, s55
    v_mov_b32 v41, 0x7ffffff0
    v_cndmask_b32 v67, v41, v40, s[56:57]
    v_cndmask_b32 v68, v41, v40, s[58:59]
    s_lshl_b32 s55, s34, 3
    v_mov_b32 v69, s55
    v_mov_b32 v70, 0
    s_lshl_b32 s55, s36, 15
    s_add_u32 s55, s55, 131072
    s_add_u32 s44, s32, s55
    s_addc_u32 s45, s33, 0
    s_mov_b32 s46, 14336
    s_mov_b32 s48, s28
    s_mov_b32 s49, s29
    s_mov_b32 s50, 2560
    v_and_b32_dpp v8, v26, v4 row_newbcast:9 row_mask:0xf bank_mask:0xf
    v_and_b32_dpp v9, v26, v5 row_newbcast:9 row_mask:0xf bank_mask:0xf
    v_and_b32_dpp v10, v26, v6 row_newbcast:9 row_mask:0xf bank_mask:0xf
    v_and_b32_dpp v11, v26, v7 row_newbcast:9 row_mask:0xf bank_mask:0xf
    s_nop 1
    v_mfma_f32_16x16x32_bf16 v[28:31], v[8:11], v[148:151], v[28:31]
    v_and_b32_dpp v12, v26, v4 row_newbcast:10 row_mask:0xf bank_mask:0xf
    v_and_b32_dpp v13, v26, v5 row_newbcast:10 row_mask:0xf bank_mask:0xf
    v_and_b32_dpp v14, v26, v6 row_newbcast:10 row_mask:0xf bank_mask:0xf
    v_and_b32_dpp v15, v26, v7 row_newbcast:10 row_mask:0xf bank_mask:0xf
    s_nop 1
    v_mfma_f32_16x16x32_bf16 v[28:31], v[12:15], v[152:155], v[28:31]
    v_and_b32_dpp v8, v26, v4 row_newbcast:11 row_mask:0xf bank_mask:0xf
    v_and_b32_dpp v9, v26, v5 row_newbcast:11 row_mask:0xf bank_mask:0xf
    v_and_b32_dpp v10, v26, v6 row_newbcast:11 row_mask:0xf bank_mask:0xf
    v_and_b32_dpp v11, v26, v7 row_newbcast:11 row_mask:0xf bank_mask:0xf
    s_nop 1
    v_mfma_f32_16x16x32_bf16 v[28:31], v[8:11], v[156:159], v[28:31]
    v_and_b32_dpp v12, v26, v4 row_newbcast:12 row_mask:0xf bank_mask:0xf
    v_and_b32_dpp v13, v26, v5 row_newbcast:12 row_mask:0xf bank_mask:0xf
    v_and_b32_dpp v14, v26, v6 row_newbcast:12 row_mask:0xf bank_mask:0xf
    v_and_b32_dpp v15, v26, v7 row_newbcast:12 row_mask:0xf bank_mask:0xf
    s_nop 1
    v_mfma_f32_16x16x32_bf16 v[28:31], v[12:15], v[160:163], v[28:31]
    v_and_b32_dpp v8, v26, v4 row_newbcast:13 row_mask:0xf bank_mask:0xf
    v_and_b32_dpp v9, v26, v5 row_newbcast:13 row_mask:0xf bank_mask:0xf
    v_and_b32_dpp v10, v26, v6 row_newbcast:13 row_mask:0xf bank_mask:0xf
    v_and_b32_dpp v11, v26, v7 row_newbcast:13 row_mask:0xf bank_mask:0xf
    s_nop 1
    v_mfma_f32_16x16x32_bf16 v[28:31], v[8:11], v[164:167], v[28:31]
    s_waitcnt vmcnt(4)
    global_load_dwordx4 v[148:151], v3, s[12:13] nt
    v_add_u32 v3, 5120, v3
    v_and_b32 v3, 0x1ffff, v3
    v_and_b32_dpp v12, v26, v4 row_newbcast:14 row_mask:0xf bank_mask:0xf
    v_and_b32_dpp v13, v26, v5 row_newbcast:14 row_mask:0xf bank_mask:0xf
    v_and_b32_dpp v14, v26, v6 row_newbcast:14 row_mask:0xf bank_mask:0xf
    v_and_b32_dpp v15, v26, v7 row_newbcast:14 row_mask:0xf bank_mask:0xf
    s_nop 1
    v_mfma_f32_16x16x32_bf16 v[28:31], v[12:15], v[168:171], v[28:31]
    s_waitcnt vmcnt(4)
    global_load_dwordx4 v[152:155], v3, s[12:13] nt
    v_add_u32 v3, 5120, v3
    v_and_b32 v3, 0x1ffff, v3
    v_and_b32_dpp v8, v26, v4 row_newbcast:15 row_mask:0xf bank_mask:0xf
    v_and_b32_dpp v9, v26, v5 row_newbcast:15 row_mask:0xf bank_mask:0xf
    v_and_b32_dpp v10, v26, v6 row_newbcast:15 row_mask:0xf bank_mask:0xf
    v_and_b32_dpp v11, v26, v7 row_newbcast:15 row_mask:0xf bank_mask:0xf
    s_nop 1
    v_mfma_f32_16x16x32_bf16 v[28:31], v[8:11], v[172:175], v[28:31]
    s_waitcnt vmcnt(4)
    global_load_dwordx4 v[156:159], v3, s[12:13] nt
    v_add_u32 v3, 5120, v3
    v_and_b32 v3, 0x1ffff, v3
    v_and_b32_dpp v12, v27, v4 row_newbcast:0 row_mask:0xf bank_mask:0xf
    v_and_b32_dpp v13, v27, v5 row_newbcast:0 row_mask:0xf bank_mask:0xf
    v_and_b32_dpp v14, v27, v6 row_newbcast:0 row_mask:0xf bank_mask:0xf
    v_and_b32_dpp v15, v27, v7 row_newbcast:0 row_mask:0xf bank_mask:0xf
    s_nop 1
    v_mfma_f32_16x16x32_bf16 v[28:31], v[12:15], v[96:99], v[28:31]
    v_and_b32_dpp v8, v27, v4 row_newbcast:1 row_mask:0xf bank_mask:0xf
    v_and_b32_dpp v9, v27, v5 row_newbcast:1 row_mask:0xf bank_mask:0xf
    v_and_b32_dpp v10, v27, v6 row_newbcast:1 row_mask:0xf bank_mask:0xf
    v_and_b32_dpp v11, v27, v7 row_newbcast:1 row_mask:0xf bank_mask:0xf
    s_nop 1
    v_mfma_f32_16x16x32_bf16 v[28:31], v[8:11], v[100:103], v[28:31]
    v_and_b32_dpp v12, v27, v4 row_newbcast:2 row_mask:0xf bank_mask:0xf
    v_and_b32_dpp v13, v27, v5 row_newbcast:2 row_mask:0xf bank_mask:0xf
    v_and_b32_dpp v14, v27, v6 row_newbcast:2 row_mask:0xf bank_mask:0xf
    v_and_b32_dpp v15, v27, v7 row_newbcast:2 row_mask:0xf bank_mask:0xf
    s_nop 1
    v_mfma_f32_16x16x32_bf16 v[28:31], v[12:15], v[104:107], v[28:31]
    v_and_b32_dpp v8, v27, v4 row_newbcast:3 row_mask:0xf bank_mask:0xf
    v_and_b32_dpp v9, v27, v5 row_newbcast:3 row_mask:0xf bank_mask:0xf
    v_and_b32_dpp v10, v27, v6 row_newbcast:3 row_mask:0xf bank_mask:0xf
    v_and_b32_dpp v11, v27, v7 row_newbcast:3 row_mask:0xf bank_mask:0xf
    s_nop 1
    v_mfma_f32_16x16x32_bf16 v[28:31], v[8:11], v[108:111], v[28:31]
    v_and_b32_dpp v12, v27, v4 row_newbcast:4 row_mask:0xf bank_mask:0xf
    v_and_b32_dpp v13, v27, v5 row_newbcast:4 row_mask:0xf bank_mask:0xf
    v_and_b32_dpp v14, v27, v6 row_newbcast:4 row_mask:0xf bank_mask:0xf
    v_and_b32_dpp v15, v27, v7 row_newbcast:4 row_mask:0xf bank_mask:0xf
    s_nop 1
    v_mfma_f32_16x16x32_bf16 v[28:31], v[12:15], v[112:115], v[28:31]
    v_and_b32_dpp v8, v27, v4 row_newbcast:5 row_mask:0xf bank_mask:0xf
    v_and_b32_dpp v9, v27, v5 row_newbcast:5 row_mask:0xf bank_mask:0xf
    v_and_b32_dpp v10, v27, v6 row_newbcast:5 row_mask:0xf bank_mask:0xf
    v_and_b32_dpp v11, v27, v7 row_newbcast:5 row_mask:0xf bank_mask:0xf
    s_nop 1
    v_mfma_f32_16x16x32_bf16 v[28:31], v[8:11], v[116:119], v[28:31]
    v_and_b32_dpp v12, v27, v4 row_newbcast:6 row_mask:0xf bank_mask:0xf
    v_and_b32_dpp v13, v27, v5 row_newbcast:6 row_mask:0xf bank_mask:0xf
    v_and_b32_dpp v14, v27, v6 row_newbcast:6 row_mask:0xf bank_mask:0xf
    v_and_b32_dpp v15, v27, v7 row_newbcast:6 row_mask:0xf bank_mask:0xf
    s_nop 1
    v_mfma_f32_16x16x32_bf16 v[28:31], v[12:15], v[120:123], v[28:31]
    v_and_b32_dpp v8, v27, v4 row_newbcast:7 row_mask:0xf bank_mask:0xf
    v_and_b32_dpp v9, v27, v5 row_newbcast:7 row_mask:0xf bank_mask:0xf
    v_and_b32_dpp v10, v27, v6 row_newbcast:7 row_mask:0xf bank_mask:0xf
    v_and_b32_dpp v11, v27, v7 row_newbcast:7 row_mask:0xf bank_mask:0xf
    s_nop 1
    v_mfma_f32_16x16x32_bf16 v[28:31], v[8:11], v[124:127], v[28:31]
    v_and_b32_dpp v12, v27, v4 row_newbcast:8 row_mask:0xf bank_mask:0xf
    v_and_b32_dpp v13, v27, v5 row_newbcast:8 row_mask:0xf bank_mask:0xf
    v_and_b32_dpp v14, v27, v6 row_newbcast:8 row_mask:0xf bank_mask:0xf
    v_and_b32_dpp v15, v27, v7 row_newbcast:8 row_mask:0xf bank_mask:0xf
    s_nop 1
    v_mfma_f32_16x16x32_bf16 v[28:31], v[12:15], v[128:131], v[28:31]
    v_and_b32_dpp v8, v27, v4 row_newbcast:9 row_mask:0xf bank_mask:0xf
    v_and_b32_dpp v9, v27, v5 row_newbcast:9 row_mask:0xf bank_mask:0xf
    v_and_b32_dpp v10, v27, v6 row_newbcast:9 row_mask:0xf bank_mask:0xf
    v_and_b32_dpp v11, v27, v7 row_newbcast:9 row_mask:0xf bank_mask:0xf
    s_nop 1
    v_mfma_f32_16x16x32_bf16 v[28:31], v[8:11], v[132:135], v[28:31]
    v_and_b32_dpp v12, v27, v4 row_newbcast:10 row_mask:0xf bank_mask:0xf
    v_and_b32_dpp v13, v27, v5 row_newbcast:10 row_mask:0xf bank_mask:0xf
    v_and_b32_dpp v14, v27, v6 row_newbcast:10 row_mask:0xf bank_mask:0xf
    v_and_b32_dpp v15, v27, v7 row_newbcast:10 row_mask:0xf bank_mask:0xf
    s_nop 1
    v_mfma_f32_16x16x32_bf16 v[28:31], v[12:15], v[136:139], v[28:31]
    s_waitcnt vmcnt(4)
    v_and_b32_dpp v8, v27, v4 row_newbcast:11 row_mask:0xf bank_mask:0xf
    v_and_b32_dpp v9, v27, v5 row_newbcast:11 row_mask:0xf bank_mask:0xf
    v_and_b32_dpp v10, v27, v6 row_newbcast:11 row_mask:0xf bank_mask:0xf
    v_and_b32_dpp v11, v27, v7 row_newbcast:11 row_mask:0xf bank_mask:0xf
    s_nop 1
    v_mfma_f32_16x16x32_bf16 v[28:31], v[8:11], v[140:143], v[28:31]
    s_waitcnt vmcnt(3)
    v_and_b32_dpp v12, v27, v4 row_newbcast:12 row_mask:0xf bank_mask:0xf
    v_and_b32_dpp v13, v27, v5 row_newbcast:12 row_mask:0xf bank_mask:0xf
    v_and_b32_dpp v14, v27, v6 row_newbcast:12 row_mask:0xf bank_mask:0xf
    v_and_b32_dpp v15, v27, v7 row_newbcast:12 row_mask:0xf bank_mask:0xf
    s_nop 1
    v_mfma_f32_16x16x32_bf16 v[28:31], v[12:15], v[144:147], v[28:31]
    s_waitcnt vmcnt(2)
    v_and_b32_dpp v8, v27, v4 row_newbcast:13 row_mask:0xf bank_mask:0xf
    v_and_b32_dpp v9, v27, v5 row_newbcast:13 row_mask:0xf bank_mask:0xf
    v_and_b32_dpp v10, v27, v6 row_newbcast:13 row_mask:0xf bank_mask:0xf
    v_and_b32_dpp v11, v27, v7 row_newbcast:13 row_mask:0xf bank_mask:0xf
    s_nop 1
    v_mfma_f32_16x16x32_bf16 v[28:31], v[8:11], v[148:151], v[28:31]
    s_waitcnt vmcnt(1)
    v_and_b32_dpp v12, v27, v4 row_newbcast:14 row_mask:0xf bank_mask:0xf
    v_and_b32_dpp v13, v27, v5 row_newbcast:14 row_mask:0xf bank_mask:0xf
    v_and_b32_dpp v14, v27, v6 row_newbcast:14 row_mask:0xf bank_mask:0xf
    v_and_b32_dpp v15, v27, v7 row_newbcast:14 row_mask:0xf bank_mask:0xf
    s_nop 1
    v_mfma_f32_16x16x32_bf16 v[28:31], v[12:15], v[152:155], v[28:31]
    s_waitcnt vmcnt(0)
    v_and_b32_dpp v8, v27, v4 row_newbcast:15 row_mask:0xf bank_mask:0xf
    v_and_b32_dpp v9, v27, v5 row_newbcast:15 row_mask:0xf bank_mask:0xf
    v_and_b32_dpp v10, v27, v6 row_newbcast:15 row_mask:0xf bank_mask:0xf
    v_and_b32_dpp v11, v27, v7 row_newbcast:15 row_mask:0xf bank_mask:0xf
    s_nop 1
    v_mfma_f32_16x16x32_bf16 v[28:31], v[8:11], v[156:159], v[28:31]
    s_nop 6
    s_mov_b32 exec_hi, 0
    ds_write_b128 v61, v[28:31] offset:0
    s_mov_b64 exec, -1
    s_waitcnt lgkmcnt(0)
    s_barrier
    ds_read2_b32 v[40:41], v62 offset0:0 offset1:128
    ds_read_b64 v[42:43], v60 offset:53376
    s_waitcnt lgkmcnt(0)
    v_mul_f32 v40, v40, v42
    v_fmac_f32 v40, v41, v43
    s_nop 1
    v_add_f32_dpp v40, v40, v40 row_ror:8 row_mask:0xf bank_mask:0xf
    v_cvt_pk_bf16_f32 v40, v40, v40
    s_nop 1
    v_and_b32_dpp v208, v40, v4 row_newbcast:0 row_mask:0xf bank_mask:0xf
    v_and_b32_dpp v209, v40, v5 row_newbcast:0 row_mask:0xf bank_mask:0xf
    v_and_b32_dpp v210, v40, v6 row_newbcast:0 row_mask:0xf bank_mask:0xf
    v_and_b32_dpp v211, v40, v7 row_newbcast:0 row_mask:0xf bank_mask:0xf
    v_and_b32_dpp v212, v40, v4 row_newbcast:1 row_mask:0xf bank_mask:0xf
    v_and_b32_dpp v213, v40, v5 row_newbcast:1 row_mask:0xf bank_mask:0xf
    v_and_b32_dpp v214, v40, v6 row_newbcast:1 row_mask:0xf bank_mask:0xf
    v_and_b32_dpp v215, v40, v7 row_newbcast:1 row_mask:0xf bank_mask:0xf
    v_mfma_f32_16x16x32_bf16 v[176:179], v[208:211], a[0:3], 0
    v_mfma_f32_16x16x32_bf16 v[180:183], v[208:211], a[4:7], 0
    v_and_b32_dpp v216, v40, v4 row_newbcast:2 row_mask:0xf bank_mask:0xf
    v_and_b32_dpp v217, v40, v5 row_newbcast:2 row_mask:0xf bank_mask:0xf
    v_and_b32_dpp v218, v40, v6 row_newbcast:2 row_mask:0xf bank_mask:0xf
    v_and_b32_dpp v219, v40, v7 row_newbcast:2 row_mask:0xf bank_mask:0xf
    v_mfma_f32_16x16x32_bf16 v[176:179], v[212:215], a[20:23], v[176:179]
    v_mfma_f32_16x16x32_bf16 v[180:183], v[212:215], a[24:27], v[180:183]
    v_and_b32_dpp v220, v40, v4 row_newbcast:3 row_mask:0xf bank_mask:0xf
    v_and_b32_dpp v221, v40, v5 row_newbcast:3 row_mask:0xf bank_mask:0xf
    v_and_b32_dpp v222, v40, v6 row_newbcast:3 row_mask:0xf bank_mask:0xf
    v_and_b32_dpp v223, v40, v7 row_newbcast:3 row_mask:0xf bank_mask:0xf
    v_mfma_f32_16x16x32_bf16 v[176:179], v[216:219], a[40:43], v[176:179]
    v_mfma_f32_16x16x32_bf16 v[180:183], v[216:219], a[44:47], v[180:183]
    v_and_b32_dpp v224, v40, v4 row_newbcast:4 row_mask:0xf bank_mask:0xf
    v_and_b32_dpp v225, v40, v5 row_newbcast:4 row_mask:0xf bank_mask:0xf
    v_and_b32_dpp v226, v40, v6 row_newbcast:4 row_mask:0xf bank_mask:0xf
    v_and_b32_dpp v227, v40, v7 row_newbcast:4 row_mask:0xf bank_mask:0xf
    v_mfma_f32_16x16x32_bf16 v[176:179], v[220:223], a[60:63], v[176:179]
    v_mfma_f32_16x16x32_bf16 v[180:183], v[220:223], a[64:67], v[180:183]
    v_and_b32_dpp v228, v40, v4 row_newbcast:5 row_mask:0xf bank_mask:0xf
    v_and_b32_dpp v229, v40, v5 row_newbcast:5 row_mask:0xf bank_mask:0xf
    v_and_b32_dpp v230, v40, v6 row_newbcast:5 row_mask:0xf bank_mask:0xf
    v_and_b32_dpp v231, v40, v7 row_newbcast:5 row_mask:0xf bank_mask:0xf
    v_mfma_f32_16x16x32_bf16 v[176:179], v[224:227], a[80:83], v[176:179]
    v_mfma_f32_16x16x32_bf16 v[180:183], v[224:227], a[84:87], v[180:183]
    v_and_b32_dpp v232, v40, v4 row_newbcast:6 row_mask:0xf bank_mask:0xf
    v_and_b32_dpp v233, v40, v5 row_newbcast:6 row_mask:0xf bank_mask:0xf
    v_and_b32_dpp v234, v40, v6 row_newbcast:6 row_mask:0xf bank_mask:0xf
    v_and_b32_dpp v235, v40, v7 row_newbcast:6 row_mask:0xf bank_mask:0xf
    v_mfma_f32_16x16x32_bf16 v[176:179], v[228:231], a[100:103], v[176:179]
    v_mfma_f32_16x16x32_bf16 v[180:183], v[228:231], a[104:107], v[180:183]
    v_and_b32_dpp v236, v40, v4 row_newbcast:7 row_mask:0xf bank_mask:0xf
    v_and_b32_dpp v237, v40, v5 row_newbcast:7 row_mask:0xf bank_mask:0xf
    v_and_b32_dpp v238, v40, v6 row_newbcast:7 row_mask:0xf bank_mask:0xf
    v_and_b32_dpp v239, v40, v7 row_newbcast:7 row_mask:0xf bank_mask:0xf
    v_mfma_f32_16x16x32_bf16 v[176:179], v[232:235], a[120:123], v[176:179]
    v_mfma_f32_16x16x32_bf16 v[180:183], v[232:235], a[124:127], v[180:183]
    v_mfma_f32_16x16x32_bf16 v[176:179], v[236:239], a[140:143], v[176:179]
    v_mfma_f32_16x16x32_bf16 v[180:183], v[236:239], a[144:147], v[180:183]
    v_mfma_f32_16x16x32_bf16 v[184:187], v[208:211], a[8:11], 0
    v_mfma_f32_16x16x32_bf16 v[184:187], v[212:215], a[28:31], v[184:187]
    v_mfma_f32_16x16x32_bf16 v[184:187], v[216:219], a[48:51], v[184:187]
    v_mfma_f32_16x16x32_bf16 v[184:187], v[220:223], a[68:71], v[184:187]
    v_mfma_f32_16x16x32_bf16 v[184:187], v[224:227], a[88:91], v[184:187]
    v_mfma_f32_16x16x32_bf16 v[184:187], v[228:231], a[108:111], v[184:187]
    v_mfma_f32_16x16x32_bf16 v[184:187], v[232:235], a[128:131], v[184:187]
    v_mfma_f32_16x16x32_bf16 v[184:187], v[236:239], a[148:151], v[184:187]
    s_mov_b32 exec_hi, 0
    ds_write_b128 v63, v[176:179] offset:16384
    s_mov_b32 exec_hi, -1
    s_mov_b32 exec_hi, 0
    ds_write_b128 v63, v[180:183] offset:16896
    s_mov_b32 exec_hi, -1
    v_mfma_f32_16x16x32_bf16 v[188:191], v[208:211], a[12:15], 0
    v_mfma_f32_16x16x32_bf16 v[188:191], v[212:215], a[32:35], v[188:191]
    v_mfma_f32_16x16x32_bf16 v[188:191], v[216:219], a[52:55], v[188:191]
    v_mfma_f32_16x16x32_bf16 v[188:191], v[220:223], a[72:75], v[188:191]
    v_mfma_f32_16x16x32_bf16 v[188:191], v[224:227], a[92:95], v[188:191]
    v_mfma_f32_16x16x32_bf16 v[188:191], v[228:231], a[112:115], v[188:191]
    v_mfma_f32_16x16x32_bf16 v[188:191], v[232:235], a[132:135], v[188:191]
    v_mfma_f32_16x16x32_bf16 v[188:191], v[236:239], a[152:155], v[188:191]
    s_mov_b32 exec_hi, 0
    ds_write_b128 v63, v[184:187] offset:17408
    s_mov_b32 exec_hi, -1
    v_mfma_f32_16x16x32_bf16 v[192:195], v[208:211], a[16:19], 0
    v_mfma_f32_16x16x32_bf16 v[192:195], v[212:215], a[36:39], v[192:195]
    v_mfma_f32_16x16x32_bf16 v[192:195], v[216:219], a[56:59], v[192:195]
    v_mfma_f32_16x16x32_bf16 v[192:195], v[220:223], a[76:79], v[192:195]
    v_mfma_f32_16x16x32_bf16 v[192:195], v[224:227], a[96:99], v[192:195]
    v_mfma_f32_16x16x32_bf16 v[192:195], v[228:231], a[116:119], v[192:195]
    v_mfma_f32_16x16x32_bf16 v[192:195], v[232:235], a[136:139], v[192:195]
    v_mfma_f32_16x16x32_bf16 v[192:195], v[236:239], a[156:159], v[192:195]
    s_mov_b32 exec_hi, 0
    ds_write_b128 v63, v[188:191] offset:17920
    s_mov_b32 exec_hi, -1
    s_nop 3
    s_mov_b32 exec_hi, 0
    ds_write_b128 v63, v[192:195] offset:18432
    s_mov_b32 exec_hi, -1
    s_mov_b64 exec, -1
    s_waitcnt lgkmcnt(0)
    s_barrier
    ds_read2st64_b32 v[40:41], v72 offset0:64 offset1:74
    ds_read2st64_b32 v[42:43], v72 offset0:84 offset1:94
    ds_read2st64_b32 v[44:45], v73 offset0:64 offset1:74
    ds_read2st64_b32 v[46:47], v73 offset0:84 offset1:94
    ds_read2st64_b32 v[48:49], v74 offset0:64 offset1:74
    ds_read2st64_b32 v[50:51], v74 offset0:84 offset1:94
    ds_read2st64_b32 v[52:53], v75 offset0:64 offset1:74
    ds_read2st64_b32 v[54:55], v75 offset0:84 offset1:94
    s_waitcnt lgkmcnt(6)
    v_add_f32 v40, v40, v41
    v_add_f32 v42, v42, v43
    v_add_f32 v40, v40, v42
    v_cndmask_b32 v40, v40, 1.0, s[4:5]
    buffer_atomic_add_f32 v40, v76, s[40:43], 0 offen sc1
    s_waitcnt lgkmcnt(4)
    v_add_f32 v44, v44, v45
    v_add_f32 v46, v46, v47
    v_add_f32 v44, v44, v46
    v_cndmask_b32 v44, v44, 1.0, s[4:5]
    buffer_atomic_add_f32 v44, v77, s[40:43], 0 offen sc1
    s_waitcnt lgkmcnt(2)
    v_add_f32 v48, v48, v49
    v_add_f32 v50, v50, v51
    v_add_f32 v48, v48, v50
    v_cndmask_b32 v48, v48, 1.0, s[4:5]
    buffer_atomic_add_f32 v48, v78, s[40:43], 0 offen sc1
    s_waitcnt lgkmcnt(0)
    v_add_f32 v52, v52, v53
    v_add_f32 v54, v54, v55
    v_add_f32 v52, v52, v54
    v_cndmask_b32 v52, v52, 0, s[6:7]
    v_cndmask_b32 v52, v52, 1.0, s[4:5]
    buffer_atomic_add_f32 v52, v79, s[40:43], 0 offen sc1
    s_cmp_eq_u32 s39, 0
    s_cbranch_scc1 Ldone
    s_cmp_lg_u32 s2, 0
    s_cbranch_scc1 Lep15
    s_cmp_lg_u32 s34, 3
    s_cbranch_scc1 Lep15
    v_mov_b32 v32, s38
    s_mov_b64 exec, 1
    global_store_dword v70, v32, s[32:33] offset:0 sc1
    s_mov_b64 exec, -1
Lep15:
    s_mov_b32 s3, 0x40000
Lpoll:
    s_movk_i32 s55, 0
    buffer_load_dwordx4 v[176:179], v66, s[44:47], s55 offen sc1
    buffer_load_dwordx4 v[180:183], v70, s[44:47], s55 offen sc1
    s_movk_i32 s55, 3584
    buffer_load_dwordx4 v[184:187], v66, s[44:47], s55 offen sc1
    buffer_load_dwordx4 v[188:191], v70, s[44:47], s55 offen sc1
    s_movk_i32 s55, 7168
    buffer_load_dwordx4 v[192:195], v66, s[44:47], s55 offen sc1
    buffer_load_dwordx4 v[196:199], v70, s[44:47], s55 offen sc1
    s_movk_i32 s55, 10752
    buffer_load_dwordx4 v[200:203], v66, s[44:47], s55 offen sc1
    buffer_load_dwordx4 v[204:207], v70, s[44:47], s55 offen sc1
    s_waitcnt vmcnt(0)
    v_min_f32 v48, v179, v183
    v_min3_f32 v48, v187, v191, v48
    v_min3_f32 v48, v195, v199, v48
    v_min3_f32 v48, v203, v207, v48
    v_cmp_gt_f32 vcc, 0x42000000, v48
    v_add_f32 v176, v176, v184
    v_add_f32 v192, v192, v200
    v_add_f32 v40, v176, v192
    v_add_f32 v177, v177, v185
    v_add_f32 v193, v193, v201
    v_add_f32 v41, v177, v193
    v_add_f32 v178, v178, v186
    v_add_f32 v194, v194, v202
    v_add_f32 v42, v178, v194
    v_add_f32 v180, v180, v188
    v_add_f32 v196, v196, v204
    v_add_f32 v43, v180, v196
    s_cbranch_vccz Lpdone
    s_sub_u32 s3, s3, 1
    s_cbranch_scc0 Lpoll
Lpdone:
    v_cvt_pk_bf16_f32 v40, 0, v40
    v_cvt_pk_bf16_f32 v41, 0, v41
    v_cvt_pk_bf16_f32 v42, 0, v42
    v_add_f32 v40, v40, v88
    v_add_f32 v41, v41, v89
    v_add_f32 v42, v42, v90
    v_add_f32 v43, v43, v91
    v_cvt_pk_bf16_f32 v40, 0, v40
    v_cvt_pk_bf16_f32 v41, 0, v41
    v_cvt_pk_bf16_f32 v42, 0, v42
    v_sub_f32 v48, v40, v43
    v_sub_f32 v49, v41, v43
    v_sub_f32 v50, v42, v43
    v_cndmask_b32 v48, 0, v48, s[56:57]
    v_cndmask_b32 v49, 0, v49, s[58:59]
    v_cndmask_b32 v50, 0, v50, s[58:59]
    v_add_f32 v52, v48, v49
    v_mul_f32 v53, v48, v48
    v_fmac_f32 v53, v49, v49
    v_add_f32 v52, v52, v50
    v_fmac_f32 v53, v50, v50
    s_nop 0
    v_add_f32_dpp v52, v52, v52 row_ror:8 row_mask:0xf bank_mask:0xf
    v_add_f32_dpp v53, v53, v53 row_ror:8 row_mask:0xf bank_mask:0xf
    s_nop 0
    v_add_f32_dpp v52, v52, v52 row_ror:4 row_mask:0xf bank_mask:0xf
    v_add_f32_dpp v53, v53, v53 row_ror:4 row_mask:0xf bank_mask:0xf
    s_nop 0
    v_add_f32_dpp v52, v52, v52 row_ror:2 row_mask:0xf bank_mask:0xf
    v_add_f32_dpp v53, v53, v53 row_ror:2 row_mask:0xf bank_mask:0xf
    s_nop 0
    v_add_f32_dpp v52, v52, v52 row_ror:1 row_mask:0xf bank_mask:0xf
    v_add_f32_dpp v53, v53, v53 row_ror:1 row_mask:0xf bank_mask:0xf
    s_nop 0
    v_add_f32_dpp v52, v52, v52 row_bcast:15 row_mask:0xa bank_mask:0xf
    v_add_f32_dpp v53, v53, v53 row_bcast:15 row_mask:0xa bank_mask:0xf
    s_nop 0
    v_add_f32_dpp v52, v52, v52 row_bcast:31 row_mask:0xc bank_mask:0xf
    v_add_f32_dpp v53, v53, v53 row_bcast:31 row_mask:0xc bank_mask:0xf
    s_mov_b32 exec_lo, 0
    s_mov_b32 exec_hi, 0x80000000
    ds_write_b64 v69, v[52:53] offset:53248
    s_mov_b64 exec, -1
    s_waitcnt lgkmcnt(0)
    s_barrier
    ds_read_b128 v[240:243], v70 offset:53248
    ds_read_b128 v[244:247], v70 offset:53264
    s_waitcnt lgkmcnt(0)
    v_pk_add_f32 v[240:241], v[240:241], v[242:243]
    v_pk_add_f32 v[244:245], v[244:245], v[246:247]
    v_pk_add_f32 v[240:241], v[240:241], v[244:245]
    v_mul_f32 v48, 0x3acccccd, v240
    v_mul_f32 v49, 0x3acccccd, v241
    v_fma_f32 v49, -v48, v48, v49
    v_add_f32 v48, v48, v43
    v_max_f32 v49, 0, v49
    v_mov_b32 v50, v48
    v_mov_b32 v54, v49
    v_cvt_pk_bf16_f32 v49, 0, v49
    v_cvt_pk_bf16_f32 v48, 0, v48
    v_add_f32 v49, 0x3727c5ac, v49
    v_sub_f32 v44, v40, v48
    v_sub_f32 v45, v41, v48
    v_sub_f32 v46, v42, v48
    v_cvt_pk_bf16_f32 v49, 0, v49
    v_sqrt_f32 v49, v49
    v_cvt_pk_bf16_f32 v44, 0, v44
    v_cvt_pk_bf16_f32 v45, 0, v45
    v_cvt_pk_bf16_f32 v46, 0, v46
    v_cvt_pk_bf16_f32 v49, 0, v49
    v_rcp_f32 v49, v49
    v_sub_f32 v50, v50, v48
    v_mul_f32 v44, v44, v49
    v_mul_f32 v45, v45, v49
    v_mul_f32 v46, v46, v49
    v_mul_f32 v47, v50, v49
    v_cvt_pk_bf16_f32 v44, 0, v44
    v_cvt_pk_bf16_f32 v45, 0, v45
    v_cvt_pk_bf16_f32 v46, 0, v46
    v_mul_f32 v54, v54, v49
    v_mul_f32 v54, v54, v49
    v_cvt_pk_bf16_f32 v47, 0, v47
    v_cvt_pk_bf16_f32 v54, 0, v54
    v_add_f32 v54, 0x3727c5ac, v54
    v_sub_f32 v248, v44, v47
    v_sub_f32 v249, v45, v47
    v_sub_f32 v250, v46, v47
    v_cvt_pk_bf16_f32 v54, 0, v54
    v_sqrt_f32 v54, v54
    v_cvt_pk_bf16_f32 v248, 0, v248
    v_cvt_pk_bf16_f32 v249, 0, v249
    v_cvt_pk_bf16_f32 v250, 0, v250
    v_cvt_pk_bf16_f32 v54, 0, v54
    v_rcp_f32 v54, v54
    s_nop 0
    v_mul_f32 v248, v248, v54
    v_mul_f32 v249, v249, v54
    v_mul_f32 v250, v250, v54
    v_cvt_pk_bf16_f32 v248, 0, v248
    v_cvt_pk_bf16_f32 v249, 0, v249
    v_cvt_pk_bf16_f32 v250, 0, v250
    v_bfe_u32 v48, v248, 16, 15
    v_bfe_u32 v49, v249, 16, 15
    v_bfe_u32 v50, v250, 16, 15
    v_subrev_u32 v48, 13824, v48
    v_ashrrev_i32 v44, 31, v248
    v_subrev_u32 v49, 13824, v49
    v_ashrrev_i32 v45, 31, v249
    v_subrev_u32 v50, 13824, v50
    v_ashrrev_i32 v46, 31, v250
    v_max3_u32 v52, v48, v49, v50
    s_movk_i32 s55, 3071
    v_min_u32 v48, s55, v48
    v_and_b32 v44, 3072, v44
    v_min_u32 v49, s55, v49
    v_and_b32 v45, 3072, v45
    v_min_u32 v50, s55, v50
    v_and_b32 v46, 3072, v46
    v_cmp_lt_u32 vcc, s55, v52
    v_add_u32 v48, v48, v44
    v_add_u32 v49, v49, v45
    v_add_u32 v50, v50, v46
    v_and_b32 v44, 2047, v48
    v_lshrrev_b32 v48, 10, v48
    v_and_b32 v45, 2047, v49
    v_lshrrev_b32 v49, 10, v49
    v_and_b32 v46, 2047, v50
    v_lshrrev_b32 v50, 10, v50
    v_and_b32 v48, 6, v48
    v_and_b32 v49, 6, v49
    v_and_b32 v50, 6, v50
    v_lshl_add_u32 v48, v44, 3, v48
    v_lshl_add_u32 v49, v45, 3, v49
    v_lshl_add_u32 v50, v46, 3, v50
    ds_read_u16 v48, v48 offset:36864
    ds_read_u16 v49, v49 offset:36864
    ds_read_u16 v50, v50 offset:36864
    s_and_b64 vcc, vcc, s[56:57]
    s_cbranch_scc1 Lslow
    s_waitcnt lgkmcnt(0)
Lback:
    v_lshlrev_b32 v48, 16, v48
    v_lshlrev_b32 v49, 16, v49
    v_lshlrev_b32 v50, 16, v50
    v_add_f32 v48, v48, v40
    v_add_f32 v49, v49, v41
    v_add_f32 v50, v50, v42
    v_cvt_pk_bf16_f32 v48, v48, v48
    v_cvt_pk_bf16_f32 v49, v49, v49
    v_cvt_pk_bf16_f32 v50, v50, v50
    buffer_store_short v48, v67, s[48:51], 0 offen
    buffer_store_short v49, v68, s[48:51], 0 offen offset:2
    buffer_store_short v50, v68, s[48:51], 0 offen offset:4
Ldone:
Lend:
    s_endpgm
Lslow:
    s_waitcnt lgkmcnt(0)
    s_mov_b64 s[52:53], vcc
    v_mov_b32 v96, v40
    v_mov_b32 v97, v41
    v_mov_b32 v98, v42
    v_mov_b32 v99, v43
    v_mov_b32 v100, v44
    v_mov_b32 v101, v45
    v_mov_b32 v102, v46
    v_mov_b32 v103, v47
    v_mov_b32 v104, v48
    v_mov_b32 v105, v49
    v_mov_b32 v106, v50
    v_mov_b32 v107, v51
    v_mov_b32 v108, v52
    v_mov_b32 v109, v53
    v_mov_b32 v110, v54
    v_mov_b32 v111, v55
Lslow1:
    s_ff1_i32_b64 s55, s[52:53]
    s_bitset0_b64 s[52:53], s55
    s_mov_b32 m0, s55
    s_nop 1
    v_readlane_b32 s56, v248, m0
    v_readlane_b32 s57, v249, m0
    v_readlane_b32 s58, v250, m0
    v_mov_b32 v80, 0
    v_mov_b32 v81, 0
    v_mov_b32 v82, 0
    v_mov_b32 v83, 0
    v_lshlrev_b32 v86, 2, v1
    s_mov_b32 s3, 13
    s_mov_b32 s59, 0
Lslow2:
    s_call_b64 s[30:31], LtabA
    s_call_b64 s[30:31], LtabB
    s_sub_u32 s3, s3, 1
    s_cbranch_scc0 Lslow2
    v_add_f32_dpp v80, v80, v80 row_ror:8 row_mask:0xf bank_mask:0xf
    v_add_f32_dpp v81, v81, v81 row_ror:8 row_mask:0xf bank_mask:0xf
    v_add_f32_dpp v82, v82, v82 row_ror:8 row_mask:0xf bank_mask:0xf
    v_add_f32_dpp v80, v80, v80 row_ror:4 row_mask:0xf bank_mask:0xf
    v_add_f32_dpp v81, v81, v81 row_ror:4 row_mask:0xf bank_mask:0xf
    v_add_f32_dpp v82, v82, v82 row_ror:4 row_mask:0xf bank_mask:0xf
    v_add_f32_dpp v80, v80, v80 row_ror:2 row_mask:0xf bank_mask:0xf
    v_add_f32_dpp v81, v81, v81 row_ror:2 row_mask:0xf bank_mask:0xf
    v_add_f32_dpp v82, v82, v82 row_ror:2 row_mask:0xf bank_mask:0xf
    v_add_f32_dpp v80, v80, v80 row_ror:1 row_mask:0xf bank_mask:0xf
    v_add_f32_dpp v81, v81, v81 row_ror:1 row_mask:0xf bank_mask:0xf
    v_add_f32_dpp v82, v82, v82 row_ror:1 row_mask:0xf bank_mask:0xf
    v_add_f32_dpp v80, v80, v80 row_bcast:15 row_mask:0xa bank_mask:0xf
    v_add_f32_dpp v81, v81, v81 row_bcast:15 row_mask:0xa bank_mask:0xf
    v_add_f32_dpp v82, v82, v82 row_bcast:15 row_mask:0xa bank_mask:0xf
    v_add_f32_dpp v80, v80, v80 row_bcast:31 row_mask:0xc bank_mask:0xf
    v_add_f32_dpp v81, v81, v81 row_bcast:31 row_mask:0xc bank_mask:0xf
    v_add_f32_dpp v82, v82, v82 row_bcast:31 row_mask:0xc bank_mask:0xf
    v_cvt_pk_bf16_f32 v80, 0, v80
    v_cvt_pk_bf16_f32 v81, 0, v81
    v_cvt_pk_bf16_f32 v82, 0, v82
    v_add_f32 v80, v80, v87
    v_add_f32 v81, v81, v87
    v_add_f32 v82, v82, v87
    v_cvt_pk_bf16_f32 v50, v80, v81
    v_cvt_pk_bf16_f32 v52, v82, v82
    s_nop 0
    v_readlane_b32 s56, v50, 63
    v_readlane_b32 s58, v52, 63
    s_nop 3
    s_lshr_b32 s57, s56, 16
    s_and_b32 s56, s56, 0xffff
    s_and_b32 s58, s58, 0xffff
    v_writelane_b32 v104, s56, m0
    v_writelane_b32 v105, s57, m0
    v_writelane_b32 v106, s58, m0
    s_cmp_lg_u64 s[52:53], 0
    s_cbranch_scc1 Lslow1
    v_mov_b32 v40, v96
    v_mov_b32 v41, v97
    v_mov_b32 v42, v98
    v_mov_b32 v43, v99
    v_mov_b32 v44, v100
    v_mov_b32 v45, v101
    v_mov_b32 v46, v102
    v_mov_b32 v47, v103
    v_mov_b32 v48, v104
    v_mov_b32 v49, v105
    v_mov_b32 v50, v106
    v_mov_b32 v51, v107
    v_mov_b32 v52, v108
    v_mov_b32 v53, v109
    v_mov_b32 v54, v110
    v_mov_b32 v55, v111
    s_branch Lback
LtabA:
    ds_read_b32 v40, v86 offset:4096
    ds_read_b32 v41, v86 offset:8192
    ds_read_b32 v72, v86 offset:12288
    v_add_u32 v86, 256, v86
    v_mov_b32 v79, 0xc0135761
    v_mov_b32 v78, 0xbdd2d3e8
    s_waitcnt lgkmcnt(0)
    v_lshlrev_b32 v73, 16, v40
    v_and_b32 v74, 0xffff0000, v40
    v_lshlrev_b32 v76, 16, v41
    v_and_b32 v77, 0xffff0000, v41
    v_mul_f32 v40, s56, v73
    v_mul_f32 v41, s56, v74
    v_mul_f32 v44, s57, v73
    v_mul_f32 v45, s57, v74
    v_cvt_pk_bf16_f32 v40, 0, v40
    v_cvt_pk_bf16_f32 v41, 0, v41
    v_cvt_pk_bf16_f32 v44, 0, v44
    v_cvt_pk_bf16_f32 v45, 0, v45
    v_pk_add_f32 v[40:41], v[40:41], v[76:77]
    v_pk_add_f32 v[44:45], v[44:45], v[76:77]
    v_cvt_pk_bf16_f32 v40, 0, v40
    v_cvt_pk_bf16_f32 v41, 0, v41
    v_cvt_pk_bf16_f32 v44, 0, v44
    v_cvt_pk_bf16_f32 v45, 0, v45
    v_pk_mul_f32 v[42:43], v[40:41], v[40:41]
    v_pk_mul_f32 v[46:47], v[44:45], v[44:45]
    v_fma_f32 v42, v42, v78, v79
    v_fma_f32 v43, v43, v78, v79
    v_fma_f32 v46, v46, v78, v79
    v_fma_f32 v47, v47, v78, v79
    v_pk_mul_f32 v[42:43], v[42:43], v[40:41]
    v_pk_mul_f32 v[46:47], v[46:47], v[44:45]
    v_exp_f32 v42, v42
    v_exp_f32 v43, v43
    v_exp_f32 v46, v46
    v_exp_f32 v47, v47
    v_add_f32 v42, 1.0, v42
    v_add_f32 v43, 1.0, v43
    v_add_f32 v46, 1.0, v46
    v_add_f32 v47, 1.0, v47
    v_rcp_f32 v42, v42
    v_rcp_f32 v43, v43
    v_rcp_f32 v46, v46
    v_rcp_f32 v47, v47
    v_pk_mul_f32 v[42:43], v[42:43], v[40:41]
    v_pk_mul_f32 v[46:47], v[46:47], v[44:45]
    v_cvt_pk_bf16_f32 v40, v42, v43
    v_cvt_pk_bf16_f32 v44, v46, v47
    v_dot2_f32_bf16 v80, v40, v72, v80
    v_dot2_f32_bf16 v81, v44, v72, v81
    s_nop 1
    s_setpc_b64 s[30:31]
LtabB:
    v_mul_f32 v40, s58, v73
    v_mul_f32 v41, s58, v74
    v_mul_f32 v44, s59, v73
    v_mul_f32 v45, s59, v74
    v_cvt_pk_bf16_f32 v40, 0, v40
    v_cvt_pk_bf16_f32 v41, 0, v41
    v_cvt_pk_bf16_f32 v44, 0, v44
    v_cvt_pk_bf16_f32 v45, 0, v45
    v_pk_add_f32 v[40:41], v[40:41], v[76:77]
    v_pk_add_f32 v[44:45], v[44:45], v[76:77]
    v_cvt_pk_bf16_f32 v40, 0, v40
    v_cvt_pk_bf16_f32 v41, 0, v41
    v_cvt_pk_bf16_f32 v44, 0, v44
    v_cvt_pk_bf16_f32 v45, 0, v45
    v_pk_mul_f32 v[42:43], v[40:41], v[40:41]
    v_pk_mul_f32 v[46:47], v[44:45], v[44:45]
    v_fma_f32 v42, v42, v78, v79
    v_fma_f32 v43, v43, v78, v79
    v_fma_f32 v46, v46, v78, v79
    v_fma_f32 v47, v47, v78, v79
    v_pk_mul_f32 v[42:43], v[42:43], v[40:41]
    v_pk_mul_f32 v[46:47], v[46:47], v[44:45]
    v_exp_f32 v42, v42
    v_exp_f32 v43, v43
    v_exp_f32 v46, v46
    v_exp_f32 v47, v47
    v_add_f32 v42, 1.0, v42
    v_add_f32 v43, 1.0, v43
    v_add_f32 v46, 1.0, v46
    v_add_f32 v47, 1.0, v47
    v_rcp_f32 v42, v42
    v_rcp_f32 v43, v43
    v_rcp_f32 v46, v46
    v_rcp_f32 v47, v47
    v_pk_mul_f32 v[42:43], v[42:43], v[40:41]
    v_pk_mul_f32 v[46:47], v[46:47], v[44:45]
    v_cvt_pk_bf16_f32 v40, v42, v43
    v_cvt_pk_bf16_f32 v44, v46, v47
    v_dot2_f32_bf16 v82, v40, v72, v82
    v_dot2_f32_bf16 v83, v44, v72, v83
    s_nop 1
    s_setpc_b64 s[30:31]
LtabC:
    v_mul_f32 v40, s60, v73
    v_mul_f32 v41, s60, v74
    v_mul_f32 v44, s61, v73
    v_mul_f32 v45, s61, v74
    v_cvt_pk_bf16_f32 v40, 0, v40
    v_cvt_pk_bf16_f32 v41, 0, v41
    v_cvt_pk_bf16_f32 v44, 0, v44
    v_cvt_pk_bf16_f32 v45, 0, v45
    v_pk_add_f32 v[40:41], v[40:41], v[76:77]
    v_pk_add_f32 v[44:45], v[44:45], v[76:77]
    v_cvt_pk_bf16_f32 v40, 0, v40
    v_cvt_pk_bf16_f32 v41, 0, v41
    v_cvt_pk_bf16_f32 v44, 0, v44
    v_cvt_pk_bf16_f32 v45, 0, v45
    v_pk_mul_f32 v[42:43], v[40:41], v[40:41]
    v_pk_mul_f32 v[46:47], v[44:45], v[44:45]
    v_fma_f32 v42, v42, v78, v79
    v_fma_f32 v43, v43, v78, v79
    v_fma_f32 v46, v46, v78, v79
    v_fma_f32 v47, v47, v78, v79
    v_pk_mul_f32 v[42:43], v[42:43], v[40:41]
    v_pk_mul_f32 v[46:47], v[46:47], v[44:45]
    v_exp_f32 v42, v42
    v_exp_f32 v43, v43
    v_exp_f32 v46, v46
    v_exp_f32 v47, v47
    v_add_f32 v42, 1.0, v42
    v_add_f32 v43, 1.0, v43
    v_add_f32 v46, 1.0, v46
    v_add_f32 v47, 1.0, v47
    v_rcp_f32 v42, v42
    v_rcp_f32 v43, v43
    v_rcp_f32 v46, v46
    v_rcp_f32 v47, v47
    v_pk_mul_f32 v[42:43], v[42:43], v[40:41]
    v_pk_mul_f32 v[46:47], v[46:47], v[44:45]
    v_cvt_pk_bf16_f32 v40, v42, v43
    v_cvt_pk_bf16_f32 v44, v46, v47
    v_dot2_f32_bf16 v84, v40, v72, v84
    v_dot2_f32_bf16 v85, v44, v72, v85
    s_nop 1
    s_setpc_b64 s[30:31]
.section .rodata,"a"
.p2align 6
.amdhsa_kernel sequential_preLN__mha_block_cached__mixer_token_mlp__decode_kernel
  .amdhsa_next_free_vgpr 416
  .amdhsa_next_free_sgpr 96
  .amdhsa_accum_offset 256
  .amdhsa_group_segment_fixed_size 0
  .amdhsa_kernarg_size 104
  .amdhsa_user_sgpr_count 2
  .amdhsa_user_sgpr_kernarg_segment_ptr 1
  .amdhsa_system_sgpr_workgroup_id_x 1
  .amdhsa_float_denorm_mode_32 3
.end_amdhsa_kernel
```
